```python
import torch

def _softmax(x, axis=-1):
    return torch.softmax(x, dim=axis)

def _gelu(x):
    return torch.nn.functional.gelu(x, approximate='tanh')

def _silu(x):
    return torch.nn.functional.silu(x)

def _sigmoid(x):
    return torch.sigmoid(x)

def _layernorm(x, axis=-1, eps=1e-05):
    m = x.mean(dim=axis, keepdim=True)
    v = x.var(dim=axis, keepdim=True, unbiased=False)
    return (x - m) / torch.sqrt(v + eps)

def _scatter_add(tgt, idx, src, axis=0):
    return tgt.clone().index_add_(axis, idx, src)

def _segment_sum(src, seg, n):
    out = torch.zeros((n,) + src.shape[1:], dtype=src.dtype)
    return out.index_add_(0, seg, src)

def _pad(x, pw):
    flat = tuple((v for pair in reversed(pw) for v in pair))
    return torch.nn.functional.pad(x, flat)
kernel_name = 'adaLN_cond__gqa_block_cached__glu_gated_geglu__decode'

def setup_inputs():

    _w = lambda a: (lambda t: t.to(torch.bfloat16) if t.is_floating_point() else t)(torch.as_tensor(a))

    def _A_setup():
        B, Sq, D = (4, 1, 512)
        Hq, Hkv, Sk, Dh = (32, 8, 8192, 128)
        assert Hq % Hkv == 0, (Hq, Hkv)
        return {'x': _w((lambda *s: torch.randn(*s, dtype=torch.bfloat16) * 0.05)(B, Sq, D)), 'k_cache': _w((lambda *s: torch.randn(*s, dtype=torch.bfloat16) * 0.8)(B, Hkv, Sk, Dh)), 'v_cache': _w((lambda *s: torch.randn(*s, dtype=torch.bfloat16) * 3.2)(B, Hkv, Sk, Dh)), 'wq': _w((lambda *s: torch.randn(*s, dtype=torch.bfloat16) * 0.8)(D, Hq * Dh) * D ** (-0.5)), 'wo': _w((lambda *s: torch.randn(*s, dtype=torch.bfloat16) * 3.2)(Hq * Dh, D) * (Hq * Dh) ** (-0.5))}
    _A_in = _A_setup()

    def _B_setup():
        B, S, Dm, Df = (4, 1, 512, 1792)
        return {'x': _w((lambda *s: torch.randn(*s, dtype=torch.bfloat16) * 0.05)(B, S, Dm)), 'w_gate': _w((lambda *s: torch.randn(*s, dtype=torch.bfloat16) * 3.2)(Dm, Df) * Dm ** (-0.5)), 'w_up': _w((lambda *s: torch.randn(*s, dtype=torch.bfloat16) * 3.2)(Dm, Df) * Dm ** (-0.5)), 'w_down': _w((lambda *s: torch.randn(*s, dtype=torch.bfloat16) * 3.2)(Df, Dm) * Df ** (-0.5))}
    _B_in = _B_setup()
    return {'A_x': _A_in['x'], 'A_k_cache': _A_in['k_cache'], 'A_v_cache': _A_in['v_cache'], 'A_wq': _A_in['wq'], 'A_wo': _A_in['wo'], 'B_x': _B_in['x'], 'B_w_gate': _B_in['w_gate'], 'B_w_up': _B_in['w_up'], 'B_w_down': _B_in['w_down'], 'c': _w((lambda *s: torch.randn(*s, dtype=torch.bfloat16) * 0.1)(4, 512) * 8.0), 'w_mod': _w((lambda *s: torch.randn(*s, dtype=torch.bfloat16) * 0.1)(512, 6 * 512) * 512 ** (-0.5) * 8.0)}

def reference(A_x, A_k_cache, A_v_cache, A_wq, A_wo, B_x, B_w_gate, B_w_up, B_w_down, c, w_mod):

    def _A_ref(x, k_cache, v_cache, wq, wo):
        B, Sq, D = x.shape
        Hq, Dh = (32, 128)
        Hkv = k_cache.shape[1]
        rep = Hq // Hkv
        q = (lambda x, *d: x.permute(*d))((x @ wq).reshape(B, Sq, Hq, Dh), 0, 2, 1, 3)
        k = (lambda x, n, axis: torch.repeat_interleave(x, n, dim=axis))(k_cache, rep, axis=1)
        v = (lambda x, n, axis: torch.repeat_interleave(x, n, dim=axis))(v_cache, rep, axis=1)
        scores = torch.einsum('bhqd,bhkd->bhqk', q, k) * Dh ** (-0.5)
        p = _softmax(scores, axis=-1)
        o = torch.einsum('bhqk,bhkd->bhqd', p, v)
        return (lambda x, *d: x.permute(*d))(o, 0, 2, 1, 3).reshape(B, Sq, Hq * Dh) @ wo

    def _B_ref(x, w_gate, w_up, w_down):
        g = torch.einsum('bsd,df->bsf', x, w_gate)
        u = torch.einsum('bsd,df->bsf', x, w_up)
        h = _gelu(g) * u
        return torch.einsum('bsf,fd->bsd', h, w_down)
    x = A_x
    mod = (_silu(c) @ w_mod).reshape(c.shape[0], 6, 1, -1)
    sa, ca, ga, sb, cb, gb = (mod[:, 0].clone(), mod[:, 1].clone(), mod[:, 2].clone(), mod[:, 3].clone(), mod[:, 4].clone(), mod[:, 5].clone())
    h = _layernorm(x, axis=-1) * (1 + ca) + sa
    x = x + ga * _A_ref(h, A_k_cache, A_v_cache, A_wq, A_wo)
    h = _layernorm(x, axis=-1) * (1 + cb) + sb
    x = x + gb * _B_ref(h, B_w_gate, B_w_up, B_w_down)
    return x
```

```asm
; @launch grid=(256,1,1) block=(512,1,1) lds=121664
.amdgcn_target "amdgcn-amd-amdhsa--gfx950"
.text
.globl adaLN_cond__gqa_block_cached__glu_gated_geglu__decode_kernel
.p2align 8
.type adaLN_cond__gqa_block_cached__glu_gated_geglu__decode_kernel,@function
adaLN_cond__gqa_block_cached__glu_gated_geglu__decode_kernel:
    s_cmp_ge_u32 s2, 256
    s_cbranch_scc1 L_exit
    s_load_dwordx16 s[4:19], s[0:1], 0
    s_load_dwordx8 s[20:27], s[0:1], 64
    s_load_dwordx4 s[28:31], s[0:1], 96
    s_getpc_b64 s[72:73]
L_pc:
    v_lshlrev_b32 v3, 6, v0
    v_cmp_gt_u32 vcc, L_code_end-L_pc, v3
    s_nop 0
    s_and_saveexec_b64 s[88:89], vcc
    s_cbranch_execz L_nopf
    global_load_dword v240, v3, s[72:73]
L_nopf:
    s_mov_b64 exec, s[88:89]
    v_lshrrev_b32 v1, 6, v0
    v_and_b32 v0, 63, v0
    s_and_b32 s60, s2, 7
    v_readfirstlane_b32 s64, v1
    s_lshr_b32 s61, s2, 3
    s_and_b32 s62, s61, 3
    s_lshr_b32 s63, s61, 2
    v_mov_b32 v3, 121344
    v_mov_b32 v4, 0
    v_mov_b32 v5, 0
    ds_write_b64 v3, v[4:5]
    s_mov_b32 s76, 0x3482a181
    s_mov_b32 s77, 0xc0a34483
    s_mov_b32 s78, 0x48424140
    s_mov_b32 s79, 0x38373e3c
    s_mov_b32 s86, 0x34464141
    s_mov_b32 s87, 0x48413942
    s_cmp_eq_u32 s62, 1
    s_cselect_b32 s76, 0xaa8aa959, s76
    s_cselect_b32 s77, 0xc0644c8b, s77
    s_cselect_b32 s78, 0x423d3d40, s78
    s_cselect_b32 s79, 0x38404847, s79
    s_cselect_b32 s86, 0x4545403d, s86
    s_cselect_b32 s87, 0x48383841, s87
    s_cmp_eq_u32 s62, 2
    s_cselect_b32 s76, 0xb292b191, s76
    s_cselect_b32 s77, 0xc02c5493, s77
    s_cselect_b32 s78, 0x47424140, s78
    s_cselect_b32 s79, 0x38454d4c, s79
    s_cselect_b32 s86, 0x45454141, s86
    s_cselect_b32 s87, 0x48333841, s87
    s_cmp_eq_u32 s62, 3
    s_cselect_b32 s76, 0xba9ab989, s76
    s_cselect_b32 s77, 0xa26b5c9b, s77
    s_cselect_b32 s78, 0x41404040, s78
    s_cselect_b32 s79, 0x3b3f4746, s79
    s_cselect_b32 s86, 0x45414040, s86
    s_cselect_b32 s87, 0x453c3841, s87
    s_lshl_b32 s72, s63, 3
    s_lshr_b64 s[76:77], s[76:77], s72
    s_and_b32 s76, s76, 255
    s_lshr_b64 s[78:79], s[78:79], s72
    s_and_b32 s78, s78, 255
    s_lshr_b64 s[86:87], s[86:87], s72
    s_and_b32 s86, s86, 255
    s_and_b32 s65, s76, 7
    s_bfe_u32 s66, s76, 0x30003
    s_lshr_b32 s83, s76, 6
    s_add_u32 s83, s83, 6
    s_lshl_b32 s72, s63, 6
    s_add_u32 s72, s72, s78
    s_sub_u32 s67, s72, 64
    s_mov_b32 s68, s86
    v_and_b32 v241, 31, v0
    v_lshlrev_b32 v241, 7, v241
    v_and_b32 v242, 7, v0
    v_lshlrev_b32 v242, 7, v242
    v_add_u32 v242, 233472, v242
    s_cmp_eq_u32 s61, 20
    s_cselect_b32 s55, s64, 0
    s_cmp_eq_u32 s55, 7
    s_cselect_b32 s55, 1, 0
    v_lshlrev_b32 v2, 4, v0
    v_and_b32 v3, 3, v0
    v_lshrrev_b32 v4, 4, v0
    v_lshlrev_b32 v5, 4, v3
    v_lshl_add_u32 v5, v4, 6, v5
    v_bfe_u32 v3, v0, 2, 2
    v_lshl_add_u32 v1, v3, 8, v5
    s_lshl_b32 s72, s62, 3
    s_add_u32 s72, s72, s60
    s_lshl_b32 s76, s72, 21
    s_add_u32 s77, s67, s64
    s_lshl_b32 s77, s77, 12
    s_add_u32 s76, s76, s77
    s_sub_u32 s34, 0x200000, s77
    s_mov_b32 s38, s34
    s_mov_b32 s35, 0x00020000
    s_mov_b32 s39, 0x00020000
    s_mov_b32 s80, 0x05040100
    s_mov_b32 s81, 0x07060302
    s_mov_b32 s82, 0x3e0293ee
    s_mov_b32 s96, 0x00003f80
    s_mov_b32 s97, 0x3f800000
    s_mov_b32 s69, 0
    s_mov_b32 s46, 0
    v_mov_b32 v54, 0
    s_lshl_b32 s91, s60, 12
    s_add_u32 s91, s91, 196608
    s_getreg_b32 s70, hwreg(HW_REG_XCC_ID, 0, 4)
    s_and_b32 s70, s70, 7
    s_lshl_b32 s79, s60, 2
    s_lshr_b32 s79, 1901343328, s79
    s_and_b32 s79, s79, 7
    s_lshl_b32 s72, s66, 3
    s_add_u32 s72, s72, s79
    s_add_u32 s73, s79, 34
    s_cmp_eq_u32 s66, 5
    s_cselect_b32 s72, s73, s72
    s_mul_i32 s73, s72, 37
    s_lshr_b32 s73, s73, 8
    s_mul_i32 s77, s73, 7
    s_sub_u32 s77, s72, s77
    s_cmp_ge_u32 s77, 3
    s_addc_u32 s77, s77, 0
    s_lshl_b32 s73, s73, 3
    s_add_u32 s72, s73, s77
    s_lshl_b32 s73, s79, 3
    s_add_u32 s73, s73, 3
    s_cmp_lt_u32 s79, 6
    s_cselect_b32 s73, s73, s72
    s_cmp_eq_u32 s66, 5
    s_cselect_b32 s72, s73, s72
    s_lshl_b32 s72, s72, 7
    s_add_u32 s72, s72, 0
    s_mul_i32 s77, s79, 5
    s_add_u32 s77, s77, s66
    s_mul_i32 s78, s77, 43
    s_lshr_b32 s78, s78, 8
    s_lshl_b32 s78, s78, 1
    s_add_u32 s77, s77, s78
    s_lshl_b32 s78, s79, 3
    s_add_u32 s78, s78, s66
    s_add_u32 s78, s78, 1
    s_cmp_lt_u32 s79, 7
    s_cselect_b32 s79, 5, 7
    s_cmp_ge_u32 s66, s79
    s_cselect_b32 s78, s78, s77
    s_lshl_b32 s78, s78, 13
    s_add_u32 s78, s78, 524288
    s_lshl_b32 s73, s60, 3
    s_add_u32 s73, s73, s66
    s_lshl_b32 s73, s73, 7
    s_add_u32 s73, s73, 32768
    s_lshl_b32 s77, s60, 12
    s_lshl_b32 s79, s66, 7
    s_add_u32 s77, s77, s79
    s_add_u32 s77, s77, 98304
    s_mov_b32 s74, s72
    s_mov_b32 s75, 6144
    s_cmp_eq_u32 s65, 1
    s_cselect_b32 s74, s73, s74
    s_cselect_b32 s75, 8192, s75
    s_cmp_eq_u32 s65, 2
    s_cselect_b32 s74, s77, s74
    s_cselect_b32 s75, 1024, s75
    s_cmp_eq_u32 s65, 4
    s_cselect_b32 s74, s78, s74
    s_waitcnt lgkmcnt(0)
    s_load_dword s95, s[30:31], 229376
    s_add_u32 s32, s6, s76
    s_addc_u32 s33, s7, 0
    s_add_u32 s36, s8, s76
    s_addc_u32 s37, s9, 0
    s_mov_b32 s40, s30
    s_mov_b32 s41, s31
    s_mov_b32 s42, 1048576
    s_mov_b32 s43, 0x00020000
    s_cmp_eq_u32 s64, 0
    s_cbranch_scc0 L_cleared
    v_mov_b32 v36, -1
    v_mov_b32 v37, -1
    v_mov_b32 v38, -1
    v_mov_b32 v39, -1
    s_cmp_eq_u32 s65, 0
    s_cbranch_scc1 L_clear_own
    s_cmp_eq_u32 s65, 4
    s_cbranch_scc1 L_clear_own
    v_lshrrev_b32 v3, 3, v0
    v_mul_lo_u32 v3, v3, s75
    v_and_b32 v4, 7, v0
    v_lshl_add_u32 v3, v4, 4, v3
    s_mov_b32 exec_hi, 0
    buffer_store_dwordx4 v[36:39], v3, s[40:43], s74 offen offset:0 sc1
    s_mov_b64 exec, -1
L_clear_own:
L_cleared:
    s_cmp_eq_u32 s65, 1
    s_cbranch_scc1 L_a_q
    s_cmp_eq_u32 s65, 3
    s_cbranch_scc0 L_a_done
    s_mov_b32 s56, s22
    s_mov_b32 s57, s23
    s_mov_b32 s58, 4096
    s_mov_b32 s59, 0x00020000
    s_lshl_b32 s72, s64, 10
    buffer_load_dwordx4 v[32:35], v2, s[56:59], s72 offen
    s_sub_u32 s72, s74, 0
    s_add_u32 s48, s24, s72
    s_addc_u32 s49, s25, 0
    s_sub_u32 s50, 3145728, s72
    s_mov_b32 s51, 0x00020000
    s_setprio 3
    v_lshrrev_b32 v3, 3, v0
    v_mul_u32_u24 v4, 6144, v3
    v_and_b32 v5, 2, v3
    v_and_b32 v3, 7, v0
    v_xor_b32 v3, v3, v5
    v_lshl_add_u32 v6, v3, 4, v4
    v_xor_b32 v3, 4, v3
    v_lshl_add_u32 v7, v3, 4, v4
    s_mul_i32 s87, s64, 393216
    s_lshl_b32 s86, s64, 13
    s_add_u32 m0, s86, 0
    s_nop 0
    buffer_load_dwordx4 v6, s[48:51], s87 offen  lds
    s_add_u32 s87, s87, 49152
    s_add_u32 m0, s86, 1024
    s_nop 0
    buffer_load_dwordx4 v7, s[48:51], s87 offen  lds
    s_add_u32 s87, s87, 49152
    s_add_u32 m0, s86, 2048
    s_nop 0
    buffer_load_dwordx4 v6, s[48:51], s87 offen  lds
    s_add_u32 s87, s87, 49152
    s_add_u32 m0, s86, 3072
    s_nop 0
    buffer_load_dwordx4 v7, s[48:51], s87 offen  lds
    s_add_u32 s87, s87, 49152
    s_add_u32 m0, s86, 4096
    s_nop 0
    buffer_load_dwordx4 v6, s[48:51], s87 offen  lds
    s_add_u32 s87, s87, 49152
    s_add_u32 m0, s86, 5120
    s_nop 0
    buffer_load_dwordx4 v7, s[48:51], s87 offen  lds
    s_add_u32 s87, s87, 49152
    s_add_u32 m0, s86, 6144
    s_nop 0
    buffer_load_dwordx4 v6, s[48:51], s87 offen  lds
    s_add_u32 s87, s87, 49152
    s_add_u32 m0, s86, 7168
    s_nop 0
    buffer_load_dwordx4 v7, s[48:51], s87 offen  lds
    s_branch L_a_done
L_a_q:
    s_mov_b32 s56, s4
    s_mov_b32 s57, s5
    s_mov_b32 s58, 4096
    s_mov_b32 s59, 0x00020000
    s_lshl_b32 s72, s64, 10
    buffer_load_dwordx4 v[32:35], v2, s[56:59], s72 offen
    s_sub_u32 s72, s74, 32768
    s_add_u32 s48, s10, s72
    s_addc_u32 s49, s11, 0
    s_sub_u32 s50, 4194304, s72
    s_mov_b32 s51, 0x00020000
    s_setprio 3
    v_lshrrev_b32 v3, 3, v0
    v_mul_u32_u24 v4, 8192, v3
    v_and_b32 v5, 2, v3
    v_and_b32 v3, 7, v0
    v_xor_b32 v3, v3, v5
    v_lshl_add_u32 v6, v3, 4, v4
    v_xor_b32 v3, 4, v3
    v_lshl_add_u32 v7, v3, 4, v4
    s_mul_i32 s87, s64, 524288
    s_lshl_b32 s86, s64, 13
    s_waitcnt vmcnt(3)
    s_add_u32 m0, s86, 0
    s_nop 0
    buffer_load_dwordx4 v6, s[48:51], s87 offen  lds
    s_add_u32 s87, s87, 65536
    s_waitcnt vmcnt(3)
    s_add_u32 m0, s86, 1024
    s_nop 0
    buffer_load_dwordx4 v7, s[48:51], s87 offen  lds
    s_add_u32 s87, s87, 65536
    s_waitcnt vmcnt(3)
    s_add_u32 m0, s86, 2048
    s_nop 0
    buffer_load_dwordx4 v6, s[48:51], s87 offen  lds
    s_add_u32 s87, s87, 65536
    s_waitcnt vmcnt(3)
    s_add_u32 m0, s86, 3072
    s_nop 0
    buffer_load_dwordx4 v7, s[48:51], s87 offen  lds
    s_add_u32 s87, s87, 65536
    s_waitcnt vmcnt(3)
    s_add_u32 m0, s86, 4096
    s_nop 0
    buffer_load_dwordx4 v6, s[48:51], s87 offen  lds
    s_add_u32 s87, s87, 65536
    s_waitcnt vmcnt(3)
    s_add_u32 m0, s86, 5120
    s_nop 0
    buffer_load_dwordx4 v7, s[48:51], s87 offen  lds
    s_add_u32 s87, s87, 65536
    s_waitcnt vmcnt(3)
    s_add_u32 m0, s86, 6144
    s_nop 0
    buffer_load_dwordx4 v6, s[48:51], s87 offen  lds
    s_add_u32 s87, s87, 65536
    s_waitcnt vmcnt(3)
    s_add_u32 m0, s86, 7168
    s_nop 0
    buffer_load_dwordx4 v7, s[48:51], s87 offen  lds
L_a_done:
    s_setprio 0
    s_cmp_eq_u32 s65, 1
    s_cbranch_scc1 L_ec_mq
    s_cmp_eq_u32 s65, 3
    s_cbranch_scc0 L_ec_done
L_ec_mq:
    s_barrier
    s_waitcnt lgkmcnt(0)
    s_mul_i32 s95, s95, 0x41c64e6d
    s_add_u32 s95, s95, 0x9e3779b8
    s_and_b32 s95, s95, 0xfffffff8
    s_or_b32 s70, s70, s95
    s_cmp_lt_u32 s64, 4
    s_cbranch_scc1 L_ec_lo
    s_waitcnt vmcnt(2)
    s_branch L_ec_done
L_ec_lo:
    s_cmp_eq_u32 s64, 0
    s_cbranch_scc0 L_rf_1
    s_lshl_b32 s72, s61, 7
    s_add_u32 s72, s72, s91
    v_lshlrev_b32 v3, 2, v0
    v_mov_b32 v4, s70
    s_mov_b32 exec_hi, 0
    s_waitcnt vmcnt(9)
    buffer_store_dword v4, v3, s[40:43], s72 offen sc1
    s_mov_b64 exec, -1
L_rf_1:
    v_lshrrev_b32 v3, 4, v0
    v_bfe_u32 v4, v0, 2, 2
    v_lshl_add_u32 v5, v3, 3, v4
    v_lshlrev_b32 v5, 7, v5
    v_and_b32 v3, 1, v3
    v_lshlrev_b32 v3, 1, v3
    v_lshrrev_b32 v4, 1, v4
    v_or_b32 v3, v3, v4
    v_xor_b32 v3, s64, v3
    v_lshl_add_u32 v5, v3, 5, v5
    v_and_b32 v4, 3, v0
    v_lshl_add_u32 v52, v4, 3, v5
    v_and_b32 v3, 3, v0
    v_mul_u32_u24 v4, 1088, v3
    v_lshrrev_b32 v5, 4, v0
    v_lshl_add_u32 v53, v5, 4, v4
    v_add_u32 v53, 98304, v53
    v_mul_lo_u32 v54, v3, s75
    v_lshl_add_u32 v54, v5, 3, v54
    s_lshl_b32 s72, s64, 5
    v_add_u32 v54, s72, v54
    s_waitcnt vmcnt(8)
    v_lshlrev_b32 v36, 16, v32
    v_and_b32 v37, 0xffff0000, v32
    v_lshlrev_b32 v38, 16, v33
    v_and_b32 v39, 0xffff0000, v33
    v_lshlrev_b32 v40, 16, v34
    v_and_b32 v41, 0xffff0000, v34
    v_lshlrev_b32 v42, 16, v35
    v_and_b32 v43, 0xffff0000, v35
    s_cmp_eq_u32 s65, 1
    s_cbranch_scc1 L_ec_q
    v_mul_f32 v44, 0xbfb8aa3b, v36
    v_mul_f32 v45, 0xbfb8aa3b, v37
    v_mul_f32 v46, 0xbfb8aa3b, v38
    v_mul_f32 v47, 0xbfb8aa3b, v39
    v_mul_f32 v48, 0xbfb8aa3b, v40
    v_mul_f32 v49, 0xbfb8aa3b, v41
    v_mul_f32 v50, 0xbfb8aa3b, v42
    v_mul_f32 v51, 0xbfb8aa3b, v43
    v_exp_f32 v44, v44
    v_exp_f32 v45, v45
    v_exp_f32 v46, v46
    v_exp_f32 v47, v47
    v_exp_f32 v48, v48
    v_exp_f32 v49, v49
    v_exp_f32 v50, v50
    v_exp_f32 v51, v51
    v_add_f32 v44, 1.0, v44
    v_add_f32 v45, 1.0, v45
    v_add_f32 v46, 1.0, v46
    v_add_f32 v47, 1.0, v47
    v_add_f32 v48, 1.0, v48
    v_add_f32 v49, 1.0, v49
    v_add_f32 v50, 1.0, v50
    v_add_f32 v51, 1.0, v51
    v_rcp_f32 v44, v44
    v_rcp_f32 v45, v45
    v_rcp_f32 v46, v46
    v_rcp_f32 v47, v47
    v_rcp_f32 v48, v48
    v_rcp_f32 v49, v49
    v_rcp_f32 v50, v50
    v_rcp_f32 v51, v51
    v_mul_f32 v36, v36, v44
    v_mul_f32 v37, v37, v45
    v_mul_f32 v38, v38, v46
    v_mul_f32 v39, v39, v47
    v_mul_f32 v40, v40, v48
    v_mul_f32 v41, v41, v49
    v_mul_f32 v42, v42, v50
    v_mul_f32 v43, v43, v51
    v_cvt_pk_bf16_f32 v32, v36, v37
    v_cvt_pk_bf16_f32 v33, v38, v39
    v_cvt_pk_bf16_f32 v34, v40, v41
    v_cvt_pk_bf16_f32 v35, v42, v43
    s_mul_i32 s72, s64, 1088
    s_add_u32 s72, s72, 98304
    v_add_u32 v3, s72, v2
    ds_write_b128 v3, v[32:35]
    s_cmp_eq_u32 s64, 0
    s_cbranch_scc1 L_ec_m0
    s_waitcnt vmcnt(0)
L_ec_m0:
    s_waitcnt vmcnt(1)
    s_waitcnt lgkmcnt(0)
    v_mov_b32 v3, 121348
    v_mov_b32 v4, 1
    s_mov_b64 exec, 1
    ds_add_u32 v3, v4
    s_mov_b64 exec, -1
    s_mov_b32 s73, 1048576
L_mb_2:
    ds_read_b32 v4, v3
    s_sub_u32 s73, s73, 1
    s_cbranch_scc1 L_mb_2_out
    s_waitcnt lgkmcnt(0)
    v_readfirstlane_b32 s72, v4
    s_nop 0
    s_cmp_ge_u32 s72, 8
    s_cbranch_scc0 L_mb_2
L_mb_2_out:
    ds_read_b64_tr_b16 v[96:97], v52 offset:0
    ds_read_b64_tr_b16 v[98:99], v52 offset:512
    ds_read_b128 v[160:163], v53 offset:0
    ds_read_b64_tr_b16 v[100:101], v52 offset:4096
    ds_read_b64_tr_b16 v[102:103], v52 offset:4608
    ds_read_b128 v[164:167], v53 offset:64
    ds_read_b64_tr_b16 v[104:105], v52 offset:8192
    ds_read_b64_tr_b16 v[106:107], v52 offset:8704
    ds_read_b128 v[168:171], v53 offset:128
    ds_read_b64_tr_b16 v[108:109], v52 offset:12288
    ds_read_b64_tr_b16 v[110:111], v52 offset:12800
    ds_read_b128 v[172:175], v53 offset:192
    ds_read_b64_tr_b16 v[112:113], v52 offset:16384
    ds_read_b64_tr_b16 v[114:115], v52 offset:16896
    ds_read_b128 v[176:179], v53 offset:256
    s_waitcnt lgkmcnt(12)
    v_mfma_f32_16x16x32_bf16 v[44:47], v[96:99], v[160:163], 0
    ds_read_b64_tr_b16 v[116:117], v52 offset:20480
    ds_read_b64_tr_b16 v[118:119], v52 offset:20992
    ds_read_b128 v[180:183], v53 offset:320
    s_waitcnt lgkmcnt(12)
    v_mfma_f32_16x16x32_bf16 v[44:47], v[100:103], v[164:167], v[44:47]
    ds_read_b64_tr_b16 v[120:121], v52 offset:24576
    ds_read_b64_tr_b16 v[122:123], v52 offset:25088
    ds_read_b128 v[184:187], v53 offset:384
    s_waitcnt lgkmcnt(12)
    v_mfma_f32_16x16x32_bf16 v[44:47], v[104:107], v[168:171], v[44:47]
    ds_read_b64_tr_b16 v[124:125], v52 offset:28672
    ds_read_b64_tr_b16 v[126:127], v52 offset:29184
    ds_read_b128 v[188:191], v53 offset:448
    s_waitcnt lgkmcnt(12)
    v_mfma_f32_16x16x32_bf16 v[44:47], v[108:111], v[172:175], v[44:47]
    ds_read_b64_tr_b16 v[128:129], v52 offset:32768
    ds_read_b64_tr_b16 v[130:131], v52 offset:33280
    ds_read_b128 v[192:195], v53 offset:512
    s_waitcnt lgkmcnt(12)
    v_mfma_f32_16x16x32_bf16 v[44:47], v[112:115], v[176:179], v[44:47]
    ds_read_b64_tr_b16 v[132:133], v52 offset:36864
    ds_read_b64_tr_b16 v[134:135], v52 offset:37376
    ds_read_b128 v[196:199], v53 offset:576
    s_waitcnt lgkmcnt(12)
    v_mfma_f32_16x16x32_bf16 v[44:47], v[116:119], v[180:183], v[44:47]
    ds_read_b64_tr_b16 v[136:137], v52 offset:40960
    ds_read_b64_tr_b16 v[138:139], v52 offset:41472
    ds_read_b128 v[200:203], v53 offset:640
    s_waitcnt lgkmcnt(12)
    v_mfma_f32_16x16x32_bf16 v[44:47], v[120:123], v[184:187], v[44:47]
    ds_read_b64_tr_b16 v[140:141], v52 offset:45056
    ds_read_b64_tr_b16 v[142:143], v52 offset:45568
    ds_read_b128 v[204:207], v53 offset:704
    s_waitcnt lgkmcnt(12)
    v_mfma_f32_16x16x32_bf16 v[44:47], v[124:127], v[188:191], v[44:47]
    ds_read_b64_tr_b16 v[144:145], v52 offset:49152
    ds_read_b64_tr_b16 v[146:147], v52 offset:49664
    ds_read_b128 v[208:211], v53 offset:768
    s_waitcnt lgkmcnt(12)
    v_mfma_f32_16x16x32_bf16 v[44:47], v[128:131], v[192:195], v[44:47]
    ds_read_b64_tr_b16 v[148:149], v52 offset:53248
    ds_read_b64_tr_b16 v[150:151], v52 offset:53760
    ds_read_b128 v[212:215], v53 offset:832
    s_waitcnt lgkmcnt(12)
    v_mfma_f32_16x16x32_bf16 v[44:47], v[132:135], v[196:199], v[44:47]
    ds_read_b64_tr_b16 v[152:153], v52 offset:57344
    ds_read_b64_tr_b16 v[154:155], v52 offset:57856
    ds_read_b128 v[216:219], v53 offset:896
    s_waitcnt lgkmcnt(12)
    v_mfma_f32_16x16x32_bf16 v[44:47], v[136:139], v[200:203], v[44:47]
    ds_read_b64_tr_b16 v[156:157], v52 offset:61440
    ds_read_b64_tr_b16 v[158:159], v52 offset:61952
    ds_read_b128 v[220:223], v53 offset:960
    s_waitcnt lgkmcnt(12)
    v_mfma_f32_16x16x32_bf16 v[44:47], v[140:143], v[204:207], v[44:47]
    s_waitcnt lgkmcnt(9)
    v_mfma_f32_16x16x32_bf16 v[44:47], v[144:147], v[208:211], v[44:47]
    s_waitcnt lgkmcnt(6)
    v_mfma_f32_16x16x32_bf16 v[44:47], v[148:151], v[212:215], v[44:47]
    s_waitcnt lgkmcnt(3)
    v_mfma_f32_16x16x32_bf16 v[44:47], v[152:155], v[216:219], v[44:47]
    s_waitcnt lgkmcnt(0)
    v_mfma_f32_16x16x32_bf16 v[44:47], v[156:159], v[220:223], v[44:47]
    s_nop 7
    v_cvt_pk_bf16_f32 v48, v44, v45
    v_cvt_pk_bf16_f32 v49, v46, v47
    v_min_u32 v48, -2, v48
    v_min_u32 v49, -2, v49
    s_mov_b32 exec_lo, 0x000f000f
    s_mov_b32 exec_hi, 0x000f000f
    buffer_store_dwordx2 v[48:49], v54, s[40:43], s74 offen sc1
    s_cmp_lt_u32 s74, 2048
    s_cbranch_scc0 L_ec_m1
    v_mov_b32 v50, v49
    v_mov_b32 v49, s95
    v_mov_b32 v51, s95
    v_and_b32 v3, 3, v0
    v_lshlrev_b32 v3, 12, v3
    v_bfe_u32 v4, v0, 4, 1
    v_lshl_add_u32 v3, v4, 10, v3
    v_lshrrev_b32 v4, 5, v0
    v_lshl_add_u32 v3, v4, 4, v3
    s_sub_u32 s73, s74, 0
    s_and_b32 s72, s73, 0x400
    s_lshl_b32 s72, s72, 1
    s_and_b32 s73, s73, 0x380
    s_add_u32 s72, s72, s73
    s_lshl_b32 s73, s64, 5
    s_add_u32 s72, s72, s73
    s_add_u32 s72, s72, 131072
    buffer_store_dwordx4 v[48:51], v3, s[40:43], s72 offen sc1
L_ec_m1:
    s_mov_b64 exec, -1
    s_branch L_ec_done
L_ec_q:
    v_readfirstlane_b32 s72, v36
    s_nop 1
    v_pk_add_f32 v[36:37], v[36:37], s[72:73] op_sel_hi:[1,0] neg_lo:[0,1] neg_hi:[0,1]
    v_pk_add_f32 v[38:39], v[38:39], s[72:73] op_sel_hi:[1,0] neg_lo:[0,1] neg_hi:[0,1]
    v_pk_add_f32 v[40:41], v[40:41], s[72:73] op_sel_hi:[1,0] neg_lo:[0,1] neg_hi:[0,1]
    v_pk_add_f32 v[42:43], v[42:43], s[72:73] op_sel_hi:[1,0] neg_lo:[0,1] neg_hi:[0,1]
    v_pk_add_f32 v[44:45], v[36:37], v[38:39]
    v_pk_mul_f32 v[46:47], v[36:37], v[36:37]
    v_pk_add_f32 v[44:45], v[44:45], v[40:41]
    v_pk_fma_f32 v[46:47], v[38:39], v[38:39], v[46:47]
    v_pk_add_f32 v[44:45], v[44:45], v[42:43]
    v_pk_fma_f32 v[46:47], v[40:41], v[40:41], v[46:47]
    v_add_f32 v44, v44, v45
    v_pk_fma_f32 v[46:47], v[42:43], v[42:43], v[46:47]
    v_add_f32 v45, v46, v47
    s_nop 1
    v_add_f32_dpp v45, v45, v45 quad_perm:[1,0,3,2] row_mask:0xf bank_mask:0xf
    v_add_f32_dpp v44, v44, v44 quad_perm:[1,0,3,2] row_mask:0xf bank_mask:0xf
    s_nop 0
    v_add_f32_dpp v45, v45, v45 quad_perm:[2,3,0,1] row_mask:0xf bank_mask:0xf
    v_add_f32_dpp v44, v44, v44 quad_perm:[2,3,0,1] row_mask:0xf bank_mask:0xf
    s_nop 0
    v_add_f32_dpp v45, v45, v45 row_ror:4 row_mask:0xf bank_mask:0xf
    v_add_f32_dpp v44, v44, v44 row_ror:4 row_mask:0xf bank_mask:0xf
    s_nop 0
    v_add_f32_dpp v45, v45, v45 row_ror:8 row_mask:0xf bank_mask:0xf
    v_add_f32_dpp v44, v44, v44 row_ror:8 row_mask:0xf bank_mask:0xf
    v_mov_b32 v47, v45
    v_mov_b32 v46, v44
    s_nop 0
    v_permlane16_swap_b32 v45, v47
    v_permlane16_swap_b32 v44, v46
    v_add_f32 v45, v45, v47
    v_add_f32 v44, v44, v46
    v_mov_b32 v47, v45
    v_mov_b32 v46, v44
    s_nop 0
    v_permlane32_swap_b32 v45, v47
    v_permlane32_swap_b32 v44, v46
    v_add_f32 v45, v45, v47
    v_add_f32 v44, v44, v46
    v_mul_f32 v44, 0x3b000000, v44
    v_mov_b32 v46, 0x3727c5ac
    v_fmac_f32 v46, 0x3b000000, v45
    v_fma_f32 v46, -v44, v44, v46
    v_max_f32 v46, 0x3727c5ac, v46
    v_rsq_f32 v45, v46
    v_sub_f32 v36, v36, v44
    v_sub_f32 v37, v37, v44
    v_sub_f32 v38, v38, v44
    v_sub_f32 v39, v39, v44
    v_sub_f32 v40, v40, v44
    v_sub_f32 v41, v41, v44
    v_sub_f32 v42, v42, v44
    v_sub_f32 v43, v43, v44
    v_mul_f32 v36, v36, v45
    v_mul_f32 v37, v37, v45
    v_mul_f32 v38, v38, v45
    v_mul_f32 v39, v39, v45
    v_mul_f32 v40, v40, v45
    v_mul_f32 v41, v41, v45
    v_mul_f32 v42, v42, v45
    v_mul_f32 v43, v43, v45
    s_mov_b32 s46, 1
    s_waitcnt vmcnt(2)
L_ec_done:
    s_mov_b32 s85, 0
    buffer_load_dwordx4 v[96:99], v1, s[32:35], s85 offen offset:0 nt
    buffer_load_dwordx4 v[100:103], v1, s[32:35], s85 offen offset:1024 nt
    buffer_load_dwordx4 v[104:107], v1, s[32:35], s85 offen offset:2048 nt
    buffer_load_dwordx4 v[108:111], v1, s[32:35], s85 offen offset:3072 nt
    v_lshlrev_b32 v8, 4, v0
    s_lshl_b32 s47, s64, 12
    s_add_u32 s47, s47, 131072
    s_cmp_eq_u32 s65, 1
    s_cbranch_scc1 L_h0_arr
    s_cmp_eq_u32 s65, 3
    s_cbranch_scc0 L_h0_plain
    s_cmp_lt_u32 s64, 4
    s_cbranch_scc1 L_h0_done
L_h0_arr:
    s_waitcnt vmcnt(4)
    v_mov_b32 v3, 121348
    v_mov_b32 v4, 1
    s_mov_b64 exec, 1
    ds_add_u32 v3, v4
    s_mov_b64 exec, -1
    s_branch L_h0_done
L_h0_plain:
    s_waitcnt lgkmcnt(0)
    s_mul_i32 s95, s95, 0x41c64e6d
    s_add_u32 s95, s95, 0x9e3779b8
    s_and_b32 s95, s95, 0xfffffff8
    s_or_b32 s70, s70, s95
    s_barrier
    s_cmp_eq_u32 s64, 0
    s_cbranch_scc0 L_rf_3
    s_lshl_b32 s72, s61, 7
    s_add_u32 s72, s72, s91
    v_lshlrev_b32 v3, 2, v0
    v_mov_b32 v4, s70
    s_mov_b32 exec_hi, 0
    s_waitcnt vmcnt(4)
    buffer_store_dword v4, v3, s[40:43], s72 offen sc1
    s_mov_b64 exec, -1
L_rf_3:
L_h0_done:
    s_lshl_b32 s76, s83, 3
    s_sub_u32 s77, s68, s76
    s_lshl_b32 s77, s77, 2
    s_add_u32 s78, s77, 7
    s_lshr_b32 s78, s78, 3
    s_mul_i32 s79, s78, s64
    s_sub_u32 s72, s77, s79
    s_cselect_b32 s72, 0, s72
    s_min_u32 s72, s72, s78
    s_sub_u32 s73, s83, 6
    s_lshl_b32 s73, s73, 2
    s_add_u32 s92, s73, s72
    s_lshl_b32 s76, s76, 2
    s_add_u32 s76, s76, s79
    s_lshl_b32 s73, s64, 2
    s_sub_u32 s76, s76, s73
    s_lshl_b32 s76, s76, 10
    s_lshl_b32 s72, s72, 10
    s_add_u32 s34, s76, s72
    s_mov_b32 s38, s34
    s_cmp_eq_u32 s83, 6
    s_cselect_b32 s78, s76, 0x400000
    s_cmp_gt_u32 s83, 6
    s_cselect_b32 s88, 196608, s78
    s_cmp_eq_u32 s83, 7
    s_cselect_b32 s78, s76, 0x400000
    s_cmp_gt_u32 s83, 7
    s_cselect_b32 s89, 229376, s78
    s_cmp_eq_u32 s83, 8
    s_cselect_b32 s78, s76, 0x400000
    s_cmp_gt_u32 s83, 8
    s_cselect_b32 s90, 262144, s78
    s_mov_b32 s85, 32768
    s_waitcnt vmcnt(3)
    buffer_load_dwordx4 v[112:115], v1, s[32:35], s85 offen offset:0 nt
    s_waitcnt vmcnt(3)
    buffer_load_dwordx4 v[116:119], v1, s[32:35], s85 offen offset:1024 nt
    s_waitcnt vmcnt(3)
    buffer_load_dwordx4 v[120:123], v1, s[32:35], s85 offen offset:2048 nt
    s_waitcnt vmcnt(3)
    buffer_load_dwordx4 v[124:127], v1, s[32:35], s85 offen offset:3072 nt
    s_mov_b32 s85, 65536
    s_waitcnt vmcnt(3)
    buffer_load_dwordx4 v[128:131], v1, s[32:35], s85 offen offset:0 nt
    s_waitcnt vmcnt(3)
    buffer_load_dwordx4 v[132:135], v1, s[32:35], s85 offen offset:1024 nt
    s_waitcnt vmcnt(3)
    buffer_load_dwordx4 v[136:139], v1, s[32:35], s85 offen offset:2048 nt
    s_waitcnt vmcnt(3)
    buffer_load_dwordx4 v[140:143], v1, s[32:35], s85 offen offset:3072 nt
    s_cmp_eq_u32 s55, 0
    s_cbranch_scc1 L_ag_4
    buffer_load_dword v243, v241, s[40:43], s91 offen sc1
L_ag_4:
    s_mov_b32 s85, 98304
    s_waitcnt vmcnt(3)
    buffer_load_dwordx4 v[144:147], v1, s[32:35], s85 offen offset:0 nt
    s_waitcnt vmcnt(3)
    buffer_load_dwordx4 v[148:151], v1, s[32:35], s85 offen offset:1024 nt
    s_waitcnt vmcnt(3)
    buffer_load_dwordx4 v[152:155], v1, s[32:35], s85 offen offset:2048 nt
    s_waitcnt vmcnt(3)
    buffer_load_dwordx4 v[156:159], v1, s[32:35], s85 offen offset:3072 nt
    s_cmp_eq_u32 s55, 0
    s_cbranch_scc1 L_ag_5
    s_waitcnt vmcnt(4)
    v_xor_b32 v3, s95, v243
    v_cmp_le_u32 vcc, 8, v3
    s_cbranch_vccnz L_ag_5_again
    v_cmp_ne_u32 vcc, s70, v243
    s_nop 0
    s_cmp_eq_u64 vcc, 0
    s_cselect_b32 s72, 1, 0
    s_or_b32 s72, s72, s95
    v_mov_b32 v4, s72
    s_lshl_b32 s72, s60, 7
    s_add_u32 s72, s72, 233472
    v_lshlrev_b32 v3, 2, v0
    s_mov_b32 exec_hi, 0
    s_cmp_eq_u64 vcc, 0
    s_cbranch_scc0 L_ag_5_nl
    s_add_u32 s73, s72, 4096
    buffer_store_dword v4, v3, s[40:43], s73 offen
L_ag_5_nl:
    buffer_store_dword v4, v3, s[40:43], s72 offen sc1
    s_mov_b64 exec, -1
    s_mov_b32 s55, 0
    s_branch L_ag_5
L_ag_5_again:
    buffer_load_dword v243, v241, s[40:43], s91 offen sc1
L_ag_5:
    s_mov_b32 s85, 131072
    s_waitcnt vmcnt(3)
    buffer_load_dwordx4 v[160:163], v1, s[32:35], s85 offen offset:0 nt
    s_waitcnt vmcnt(3)
    buffer_load_dwordx4 v[164:167], v1, s[32:35], s85 offen offset:1024 nt
    s_waitcnt vmcnt(3)
    buffer_load_dwordx4 v[168:171], v1, s[32:35], s85 offen offset:2048 nt
    s_waitcnt vmcnt(3)
    buffer_load_dwordx4 v[172:175], v1, s[32:35], s85 offen offset:3072 nt
    s_cmp_eq_u32 s46, 0
    s_cbranch_scc1 L_qs_6
    buffer_load_dwordx4 v[56:59], v8, s[40:43], s47 offen offset:0 sc1
    buffer_load_dwordx4 v[60:63], v8, s[40:43], s47 offen offset:1024 sc1
    buffer_load_dwordx4 v[64:67], v8, s[40:43], s47 offen offset:2048 sc1
    buffer_load_dwordx4 v[68:71], v8, s[40:43], s47 offen offset:3072 sc1
    s_lshl_b32 s72, s60, 7
    s_add_u32 s72, s72, 237568
    buffer_load_dword v244, off, s[40:43], s72 sc1
L_qs_6:
    s_cmp_eq_u32 s55, 0
    s_cbranch_scc1 L_ag_7
    s_waitcnt vmcnt(4)
    v_xor_b32 v3, s95, v243
    v_cmp_le_u32 vcc, 8, v3
    s_cbranch_vccnz L_agw_8_spin
L_agw_8_ok:
    v_cmp_ne_u32 vcc, s70, v243
    s_nop 0
    s_cmp_eq_u64 vcc, 0
    s_cselect_b32 s72, 1, 0
    s_or_b32 s72, s72, s95
    v_mov_b32 v4, s72
    s_lshl_b32 s72, s60, 7
    s_add_u32 s72, s72, 233472
    v_lshlrev_b32 v3, 2, v0
    s_mov_b32 exec_hi, 0
    s_cmp_eq_u64 vcc, 0
    s_cbranch_scc0 L_ag_7_nl
    s_add_u32 s73, s72, 4096
    buffer_store_dword v4, v3, s[40:43], s73 offen
L_ag_7_nl:
    buffer_store_dword v4, v3, s[40:43], s72 offen sc1
    s_mov_b64 exec, -1
    s_mov_b32 s55, 0
    s_branch L_ag_7
L_ag_7_again:
L_ag_7:
    s_mov_b32 s85, 163840
    s_waitcnt vmcnt(3)
    buffer_load_dwordx4 v[176:179], v1, s[32:35], s85 offen offset:0 nt
    s_waitcnt vmcnt(3)
    buffer_load_dwordx4 v[180:183], v1, s[32:35], s85 offen offset:1024 nt
    s_waitcnt vmcnt(3)
    buffer_load_dwordx4 v[184:187], v1, s[32:35], s85 offen offset:2048 nt
    s_waitcnt vmcnt(3)
    buffer_load_dwordx4 v[188:191], v1, s[32:35], s85 offen offset:3072 nt
    s_cmp_eq_u32 s46, 0
    s_cbranch_scc1 L_qs_9
    s_waitcnt vmcnt(4)
    s_call_b64 s[44:45], L_qsub
L_qs_9:
    s_cmp_le_u32 s92, 0
    s_cbranch_scc1 L_k_done
    s_waitcnt vmcnt(3)
    buffer_load_dwordx4 v[192:195], v1, s[32:35], s88 offen offset:0 nt
    s_cmp_le_u32 s92, 1
    s_cbranch_scc1 L_k_done
    s_waitcnt vmcnt(3)
    buffer_load_dwordx4 v[196:199], v1, s[32:35], s88 offen offset:1024 nt
    s_cmp_le_u32 s92, 2
    s_cbranch_scc1 L_k_done
    s_waitcnt vmcnt(3)
    buffer_load_dwordx4 v[200:203], v1, s[32:35], s88 offen offset:2048 nt
    s_cmp_le_u32 s92, 3
    s_cbranch_scc1 L_k_done
    s_waitcnt vmcnt(3)
    buffer_load_dwordx4 v[204:207], v1, s[32:35], s88 offen offset:3072 nt
    s_cmp_eq_u32 s46, 0
    s_cbranch_scc1 L_qs_10
    s_waitcnt vmcnt(4)
    s_call_b64 s[44:45], L_qsub
L_qs_10:
    s_cmp_le_u32 s92, 4
    s_cbranch_scc1 L_k_done
    s_waitcnt vmcnt(3)
    buffer_load_dwordx4 v[208:211], v1, s[32:35], s89 offen offset:0 nt
    s_cmp_le_u32 s92, 5
    s_cbranch_scc1 L_k_done
    s_waitcnt vmcnt(3)
    buffer_load_dwordx4 v[212:215], v1, s[32:35], s89 offen offset:1024 nt
    s_cmp_le_u32 s92, 6
    s_cbranch_scc1 L_k_done
    s_waitcnt vmcnt(3)
    buffer_load_dwordx4 v[216:219], v1, s[32:35], s89 offen offset:2048 nt
    s_cmp_le_u32 s92, 7
    s_cbranch_scc1 L_k_done
    s_waitcnt vmcnt(3)
    buffer_load_dwordx4 v[220:223], v1, s[32:35], s89 offen offset:3072 nt
    s_cmp_eq_u32 s46, 0
    s_cbranch_scc1 L_qs_11
    s_waitcnt vmcnt(4)
    s_call_b64 s[44:45], L_qsub
L_qs_11:
    s_cmp_le_u32 s92, 8
    s_cbranch_scc1 L_k_done
    s_waitcnt vmcnt(3)
    buffer_load_dwordx4 v[224:227], v1, s[32:35], s90 offen offset:0 nt
    s_cmp_le_u32 s92, 9
    s_cbranch_scc1 L_k_done
    s_waitcnt vmcnt(3)
    buffer_load_dwordx4 v[228:231], v1, s[32:35], s90 offen offset:1024 nt
    s_cmp_le_u32 s92, 10
    s_cbranch_scc1 L_k_done
    s_waitcnt vmcnt(3)
    buffer_load_dwordx4 v[232:235], v1, s[32:35], s90 offen offset:2048 nt
    s_cmp_le_u32 s92, 11
    s_cbranch_scc1 L_k_done
    s_waitcnt vmcnt(3)
    buffer_load_dwordx4 v[236:239], v1, s[32:35], s90 offen offset:3072 nt
L_k_done:
    s_cmp_eq_u32 s46, 0
    s_cbranch_scc1 L_qs_12
    s_mov_b32 s71, 0
L_qs_12_loop:
    s_waitcnt vmcnt(0)
    s_call_b64 s[44:45], L_qsub
    s_add_u32 s71, s71, 1
    s_cmp_ge_u32 s71, 200000
    s_cbranch_scc1 L_qs_12
    s_cmp_eq_u32 s46, 0
    s_cbranch_scc0 L_qs_12_loop
L_qs_12:
    s_cmp_eq_u32 s65, 2
    s_cbranch_scc0 L_ao_done
    s_lshl_b32 s72, s60, 19
    s_lshl_b32 s73, s66, 7
    s_add_u32 s72, s72, s73
    s_add_u32 s48, s12, s72
    s_addc_u32 s49, s13, 0
    s_sub_u32 s50, 4194304, s72
    s_mov_b32 s51, 0x00020000
    v_lshrrev_b32 v3, 3, v0
    v_mul_u32_u24 v4, 1024, v3
    v_and_b32 v5, 2, v3
    v_and_b32 v3, 7, v0
    v_xor_b32 v3, v3, v5
    v_lshl_add_u32 v6, v3, 4, v4
    v_xor_b32 v3, 4, v3
    v_lshl_add_u32 v7, v3, 4, v4
    s_mul_i32 s87, s64, 65536
    s_lshl_b32 s86, s64, 13
    s_waitcnt vmcnt(3)
    s_add_u32 m0, s86, 0
    s_nop 0
    buffer_load_dwordx4 v6, s[48:51], s87 offen  lds
    s_add_u32 s87, s87, 8192
    s_waitcnt vmcnt(3)
    s_add_u32 m0, s86, 1024
    s_nop 0
    buffer_load_dwordx4 v7, s[48:51], s87 offen  lds
    s_add_u32 s87, s87, 8192
    s_waitcnt vmcnt(3)
    s_add_u32 m0, s86, 2048
    s_nop 0
    buffer_load_dwordx4 v6, s[48:51], s87 offen  lds
    s_add_u32 s87, s87, 8192
    s_waitcnt vmcnt(3)
    s_add_u32 m0, s86, 3072
    s_nop 0
    buffer_load_dwordx4 v7, s[48:51], s87 offen  lds
    s_add_u32 s87, s87, 8192
    s_waitcnt vmcnt(3)
    s_add_u32 m0, s86, 4096
    s_nop 0
    buffer_load_dwordx4 v6, s[48:51], s87 offen  lds
    s_add_u32 s87, s87, 8192
    s_waitcnt vmcnt(3)
    s_add_u32 m0, s86, 5120
    s_nop 0
    buffer_load_dwordx4 v7, s[48:51], s87 offen  lds
    s_add_u32 s87, s87, 8192
    s_waitcnt vmcnt(3)
    s_add_u32 m0, s86, 6144
    s_nop 0
    buffer_load_dwordx4 v6, s[48:51], s87 offen  lds
    s_add_u32 s87, s87, 8192
    s_waitcnt vmcnt(3)
    s_add_u32 m0, s86, 7168
    s_nop 0
    buffer_load_dwordx4 v7, s[48:51], s87 offen  lds
L_ao_done:
    s_cmp_eq_u32 s65, 4
    s_cbranch_scc0 L_a2_done
    s_sub_u32 s72, s74, 524288
    s_lshr_b32 s72, s72, 7
    s_add_u32 s48, s16, s72
    s_addc_u32 s49, s17, 0
    s_sub_u32 s50, 1835008, s72
    s_mov_b32 s51, 0x00020000
    s_add_u32 s52, s18, s72
    s_addc_u32 s53, s19, 0
    s_mov_b32 s54, s50
    s_mov_b32 s55, 0x00020000
    v_lshrrev_b32 v3, 2, v0
    v_mul_u32_u24 v4, 3584, v3
    v_lshrrev_b32 v3, 3, v3
    v_and_b32 v5, 3, v0
    v_xor_b32 v5, v5, v3
    v_lshl_add_u32 v6, v5, 4, v4
    v_xor_b32 v5, 2, v5
    v_lshl_add_u32 v7, v5, 4, v4
    s_mul_i32 s87, s64, 229376
    s_lshl_b32 s86, s64, 12
    s_waitcnt vmcnt(3)
    s_add_u32 m0, s86, 0
    s_nop 0
    buffer_load_dwordx4 v6, s[48:51], s87 offen  lds
    s_waitcnt vmcnt(3)
    s_add_u32 m0, s86, 32768
    s_nop 0
    buffer_load_dwordx4 v7, s[52:55], s87 offen  lds
    s_add_u32 s87, s87, 57344
    s_waitcnt vmcnt(3)
    s_add_u32 m0, s86, 1024
    s_nop 0
    buffer_load_dwordx4 v6, s[48:51], s87 offen  lds
    s_waitcnt vmcnt(3)
    s_add_u32 m0, s86, 33792
    s_nop 0
    buffer_load_dwordx4 v7, s[52:55], s87 offen  lds
    s_add_u32 s87, s87, 57344
    s_waitcnt vmcnt(3)
    s_add_u32 m0, s86, 2048
    s_nop 0
    buffer_load_dwordx4 v6, s[48:51], s87 offen  lds
    s_waitcnt vmcnt(3)
    s_add_u32 m0, s86, 34816
    s_nop 0
    buffer_load_dwordx4 v7, s[52:55], s87 offen  lds
    s_add_u32 s87, s87, 57344
    s_waitcnt vmcnt(3)
    s_add_u32 m0, s86, 3072
    s_nop 0
    buffer_load_dwordx4 v6, s[48:51], s87 offen  lds
    s_waitcnt vmcnt(3)
    s_add_u32 m0, s86, 35840
    s_nop 0
    buffer_load_dwordx4 v7, s[52:55], s87 offen  lds
    s_sub_u32 s72, s74, 524288
    s_lshl_b32 s72, s72, 2
    s_lshl_b32 s73, s64, 12
    s_add_u32 s72, s72, s73
    s_add_u32 s56, s20, s72
    s_addc_u32 s57, s21, 0
    s_mov_b32 s58, 4096
    s_mov_b32 s59, 0x00020000
    v_xor_b32 v3, 0, v0
    v_lshlrev_b32 v3, 4, v3
    v_add_u32 v3, 0, v3
    s_waitcnt vmcnt(3)
    s_add_u32 m0, s86, 65536
    s_nop 0
    buffer_load_dwordx4 v3, s[56:59], 0 offen  lds
    v_xor_b32 v3, 8, v0
    v_lshlrev_b32 v3, 4, v3
    v_add_u32 v3, 1024, v3
    s_waitcnt vmcnt(3)
    s_add_u32 m0, s86, 66560
    s_nop 0
    buffer_load_dwordx4 v3, s[56:59], 0 offen  lds
    v_xor_b32 v3, 1, v0
    v_lshlrev_b32 v3, 4, v3
    v_add_u32 v3, 2048, v3
    s_waitcnt vmcnt(3)
    s_add_u32 m0, s86, 67584
    s_nop 0
    buffer_load_dwordx4 v3, s[56:59], 0 offen  lds
    v_xor_b32 v3, 9, v0
    v_lshlrev_b32 v3, 4, v3
    v_add_u32 v3, 3072, v3
    s_waitcnt vmcnt(3)
    s_add_u32 m0, s86, 68608
    s_nop 0
    buffer_load_dwordx4 v3, s[56:59], 0 offen  lds
L_a2_done:
    buffer_load_dword v240, v242, s[40:43], 0 offen sc1
    s_mov_b32 s85, 0
    s_waitcnt vmcnt(3)
    buffer_load_dwordx4 v[32:35], v2, s[36:39], s85 offen offset:0 nt
    s_waitcnt vmcnt(3)
    buffer_load_dwordx4 v[36:39], v2, s[36:39], s85 offen offset:1024 nt
    s_waitcnt vmcnt(3)
    buffer_load_dwordx4 v[40:43], v2, s[36:39], s85 offen offset:2048 nt
    s_waitcnt vmcnt(3)
    buffer_load_dwordx4 v[44:47], v2, s[36:39], s85 offen offset:3072 nt
    s_waitcnt vmcnt(4)
    v_xor_b32 v3, s95, v240
    v_cmp_le_u32 vcc, 8, v3
    s_cbranch_vccnz L_fl_13_spin
L_fl_13_ok:
    v_readlane_b32 s69, v240, s60
    s_nop 0
    s_and_b32 s69, s69, 1
    s_cmp_eq_u32 s64, 0
    s_cbranch_scc0 L_cp_done
    v_mov_b32 v16, -1
    v_mov_b32 v17, -1
    v_mov_b32 v18, -1
    v_mov_b32 v19, -1
    s_lshl_b32 s72, s60, 5
    s_add_u32 s72, s72, s61
    s_lshl_b32 s72, s72, 10
    s_add_u32 s72, s72, 262144
    s_cmp_eq_u32 s69, 0
    s_cbranch_scc1 L_st_14_slow
    buffer_store_dwordx4 v[16:19], v2, s[40:43], s72 offen
L_st_14_done:
L_cp_done:
    s_mov_b32 s85, 32768
    s_waitcnt vmcnt(3)
    buffer_load_dwordx4 v[48:51], v2, s[36:39], s85 offen offset:0 nt
    s_waitcnt vmcnt(3)
    buffer_load_dwordx4 v[52:55], v2, s[36:39], s85 offen offset:1024 nt
    s_waitcnt vmcnt(3)
    buffer_load_dwordx4 v[56:59], v2, s[36:39], s85 offen offset:2048 nt
    s_waitcnt vmcnt(3)
    buffer_load_dwordx4 v[60:63], v2, s[36:39], s85 offen offset:3072 nt
    v_and_b32 v3, 3, v0
    v_lshlrev_b32 v3, 8, v3
    v_lshrrev_b32 v4, 4, v0
    v_lshl_add_u32 v3, v4, 6, v3
    v_bfe_u32 v4, v0, 2, 2
    v_lshl_add_u32 v3, v4, 4, v3
    s_lshl_b32 s73, s62, 13
    s_lshl_b32 s72, s60, 10
    s_add_u32 s73, s73, s72
    s_add_u32 s73, s73, 32768
    buffer_load_dwordx4 v[12:15], v3, s[40:43], s73 offen sc1
    s_mov_b32 s85, 65536
    s_waitcnt vmcnt(3)
    buffer_load_dwordx4 v[64:67], v2, s[36:39], s85 offen offset:0 nt
    s_waitcnt vmcnt(3)
    buffer_load_dwordx4 v[68:71], v2, s[36:39], s85 offen offset:1024 nt
    s_waitcnt vmcnt(3)
    buffer_load_dwordx4 v[72:75], v2, s[36:39], s85 offen offset:2048 nt
    s_waitcnt vmcnt(3)
    buffer_load_dwordx4 v[76:79], v2, s[36:39], s85 offen offset:3072 nt
    s_waitcnt vmcnt(4)
    v_max3_u32 v4, v12, v13, v14
    v_max_u32 v4, v15, v4
    v_cmp_eq_u32 vcc, -1, v4
    s_cbranch_vccnz L_pq_15_spin
L_pq_15_ok:
    s_mov_b32 s85, 98304
    buffer_load_dwordx4 v[80:83], v2, s[36:39], s85 offen offset:0 nt
    buffer_load_dwordx4 v[84:87], v2, s[36:39], s85 offen offset:1024 nt
    buffer_load_dwordx4 v[88:91], v2, s[36:39], s85 offen offset:2048 nt
    buffer_load_dwordx4 v[92:95], v2, s[36:39], s85 offen offset:3072 nt
    v_mov_b32 v4, 0xff800000
    v_mfma_f32_16x16x32_bf16 v[16:19], v[96:99], v[12:15], 0
    v_mfma_f32_16x16x32_bf16 v[20:23], v[100:103], v[12:15], 0
    v_mfma_f32_16x16x32_bf16 v[24:27], v[104:107], v[12:15], 0
    v_mfma_f32_16x16x32_bf16 v[28:31], v[108:111], v[12:15], 0
    v_mfma_f32_16x16x32_bf16 v[96:99], v[112:115], v[12:15], 0
    v_mfma_f32_16x16x32_bf16 v[100:103], v[116:119], v[12:15], 0
    v_mfma_f32_16x16x32_bf16 v[104:107], v[120:123], v[12:15], 0
    v_mfma_f32_16x16x32_bf16 v[108:111], v[124:127], v[12:15], 0
    s_nop 0
    v_add_f32_dpp v16, v17, v16 row_shl:4 row_mask:0xf bank_mask:0xf
    v_add_f32_dpp v20, v21, v20 row_shl:4 row_mask:0xf bank_mask:0xf
    v_add_f32_dpp v24, v25, v24 row_shl:4 row_mask:0xf bank_mask:0xf
    v_add_f32_dpp v28, v29, v28 row_shl:4 row_mask:0xf bank_mask:0xf
    v_add_f32_dpp v16, v18, v16 row_shl:8 row_mask:0xf bank_mask:0xf
    v_add_f32_dpp v20, v22, v20 row_shl:8 row_mask:0xf bank_mask:0xf
    v_add_f32_dpp v24, v26, v24 row_shl:8 row_mask:0xf bank_mask:0xf
    v_add_f32_dpp v28, v30, v28 row_shl:8 row_mask:0xf bank_mask:0xf
    v_add_f32_dpp v16, v19, v16 row_shl:12 row_mask:0xf bank_mask:0xf
    v_add_f32_dpp v20, v23, v20 row_shl:12 row_mask:0xf bank_mask:0xf
    v_add_f32_dpp v24, v27, v24 row_shl:12 row_mask:0xf bank_mask:0xf
    v_add_f32_dpp v28, v31, v28 row_shl:12 row_mask:0xf bank_mask:0xf
    v_mfma_f32_16x16x32_bf16 v[112:115], v[128:131], v[12:15], 0
    v_mfma_f32_16x16x32_bf16 v[116:119], v[132:135], v[12:15], 0
    v_mfma_f32_16x16x32_bf16 v[120:123], v[136:139], v[12:15], 0
    v_mfma_f32_16x16x32_bf16 v[124:127], v[140:143], v[12:15], 0
    v_add_f32_dpp v96, v97, v96 row_shl:4 row_mask:0xf bank_mask:0xf
    v_add_f32_dpp v100, v101, v100 row_shl:4 row_mask:0xf bank_mask:0xf
    v_add_f32_dpp v104, v105, v104 row_shl:4 row_mask:0xf bank_mask:0xf
    v_add_f32_dpp v108, v109, v108 row_shl:4 row_mask:0xf bank_mask:0xf
    v_add_f32_dpp v96, v98, v96 row_shl:8 row_mask:0xf bank_mask:0xf
    v_add_f32_dpp v100, v102, v100 row_shl:8 row_mask:0xf bank_mask:0xf
    v_add_f32_dpp v104, v106, v104 row_shl:8 row_mask:0xf bank_mask:0xf
    v_add_f32_dpp v108, v110, v108 row_shl:8 row_mask:0xf bank_mask:0xf
    v_add_f32_dpp v96, v99, v96 row_shl:12 row_mask:0xf bank_mask:0xf
    v_add_f32_dpp v100, v103, v100 row_shl:12 row_mask:0xf bank_mask:0xf
    v_add_f32_dpp v104, v107, v104 row_shl:12 row_mask:0xf bank_mask:0xf
    v_add_f32_dpp v108, v111, v108 row_shl:12 row_mask:0xf bank_mask:0xf
    v_mfma_f32_16x16x32_bf16 v[128:131], v[144:147], v[12:15], 0
    v_mfma_f32_16x16x32_bf16 v[132:135], v[148:151], v[12:15], 0
    v_mfma_f32_16x16x32_bf16 v[136:139], v[152:155], v[12:15], 0
    v_mfma_f32_16x16x32_bf16 v[140:143], v[156:159], v[12:15], 0
    v_add_f32_dpp v112, v113, v112 row_shl:4 row_mask:0xf bank_mask:0xf
    v_add_f32_dpp v116, v117, v116 row_shl:4 row_mask:0xf bank_mask:0xf
    v_add_f32_dpp v120, v121, v120 row_shl:4 row_mask:0xf bank_mask:0xf
    v_add_f32_dpp v124, v125, v124 row_shl:4 row_mask:0xf bank_mask:0xf
    v_add_f32_dpp v112, v114, v112 row_shl:8 row_mask:0xf bank_mask:0xf
    v_add_f32_dpp v116, v118, v116 row_shl:8 row_mask:0xf bank_mask:0xf
    v_add_f32_dpp v120, v122, v120 row_shl:8 row_mask:0xf bank_mask:0xf
    v_add_f32_dpp v124, v126, v124 row_shl:8 row_mask:0xf bank_mask:0xf
    v_add_f32_dpp v112, v115, v112 row_shl:12 row_mask:0xf bank_mask:0xf
    v_add_f32_dpp v116, v119, v116 row_shl:12 row_mask:0xf bank_mask:0xf
    v_add_f32_dpp v120, v123, v120 row_shl:12 row_mask:0xf bank_mask:0xf
    v_add_f32_dpp v124, v127, v124 row_shl:12 row_mask:0xf bank_mask:0xf
    v_mfma_f32_16x16x32_bf16 v[144:147], v[160:163], v[12:15], 0
    v_mfma_f32_16x16x32_bf16 v[148:151], v[164:167], v[12:15], 0
    v_mfma_f32_16x16x32_bf16 v[152:155], v[168:171], v[12:15], 0
    v_mfma_f32_16x16x32_bf16 v[156:159], v[172:175], v[12:15], 0
    v_add_f32_dpp v128, v129, v128 row_shl:4 row_mask:0xf bank_mask:0xf
    v_add_f32_dpp v132, v133, v132 row_shl:4 row_mask:0xf bank_mask:0xf
    v_add_f32_dpp v136, v137, v136 row_shl:4 row_mask:0xf bank_mask:0xf
    v_add_f32_dpp v140, v141, v140 row_shl:4 row_mask:0xf bank_mask:0xf
    v_add_f32_dpp v128, v130, v128 row_shl:8 row_mask:0xf bank_mask:0xf
    v_add_f32_dpp v132, v134, v132 row_shl:8 row_mask:0xf bank_mask:0xf
    v_add_f32_dpp v136, v138, v136 row_shl:8 row_mask:0xf bank_mask:0xf
    v_add_f32_dpp v140, v142, v140 row_shl:8 row_mask:0xf bank_mask:0xf
    v_add_f32_dpp v128, v131, v128 row_shl:12 row_mask:0xf bank_mask:0xf
    v_add_f32_dpp v132, v135, v132 row_shl:12 row_mask:0xf bank_mask:0xf
    v_add_f32_dpp v136, v139, v136 row_shl:12 row_mask:0xf bank_mask:0xf
    v_add_f32_dpp v140, v143, v140 row_shl:12 row_mask:0xf bank_mask:0xf
    v_mfma_f32_16x16x32_bf16 v[160:163], v[176:179], v[12:15], 0
    v_mfma_f32_16x16x32_bf16 v[164:167], v[180:183], v[12:15], 0
    v_mfma_f32_16x16x32_bf16 v[168:171], v[184:187], v[12:15], 0
    v_mfma_f32_16x16x32_bf16 v[172:175], v[188:191], v[12:15], 0
    v_add_f32_dpp v144, v145, v144 row_shl:4 row_mask:0xf bank_mask:0xf
    v_add_f32_dpp v148, v149, v148 row_shl:4 row_mask:0xf bank_mask:0xf
    v_add_f32_dpp v152, v153, v152 row_shl:4 row_mask:0xf bank_mask:0xf
    v_add_f32_dpp v156, v157, v156 row_shl:4 row_mask:0xf bank_mask:0xf
    v_add_f32_dpp v144, v146, v144 row_shl:8 row_mask:0xf bank_mask:0xf
    v_add_f32_dpp v148, v150, v148 row_shl:8 row_mask:0xf bank_mask:0xf
    v_add_f32_dpp v152, v154, v152 row_shl:8 row_mask:0xf bank_mask:0xf
    v_add_f32_dpp v156, v158, v156 row_shl:8 row_mask:0xf bank_mask:0xf
    v_add_f32_dpp v144, v147, v144 row_shl:12 row_mask:0xf bank_mask:0xf
    v_add_f32_dpp v148, v151, v148 row_shl:12 row_mask:0xf bank_mask:0xf
    v_add_f32_dpp v152, v155, v152 row_shl:12 row_mask:0xf bank_mask:0xf
    v_add_f32_dpp v156, v159, v156 row_shl:12 row_mask:0xf bank_mask:0xf
    v_mfma_f32_16x16x32_bf16 v[176:179], v[192:195], v[12:15], 0
    v_mfma_f32_16x16x32_bf16 v[180:183], v[196:199], v[12:15], 0
    v_mfma_f32_16x16x32_bf16 v[184:187], v[200:203], v[12:15], 0
    v_mfma_f32_16x16x32_bf16 v[188:191], v[204:207], v[12:15], 0
    v_add_f32_dpp v160, v161, v160 row_shl:4 row_mask:0xf bank_mask:0xf
    v_add_f32_dpp v164, v165, v164 row_shl:4 row_mask:0xf bank_mask:0xf
    v_add_f32_dpp v168, v169, v168 row_shl:4 row_mask:0xf bank_mask:0xf
    v_add_f32_dpp v172, v173, v172 row_shl:4 row_mask:0xf bank_mask:0xf
    v_add_f32_dpp v160, v162, v160 row_shl:8 row_mask:0xf bank_mask:0xf
    v_add_f32_dpp v164, v166, v164 row_shl:8 row_mask:0xf bank_mask:0xf
    v_add_f32_dpp v168, v170, v168 row_shl:8 row_mask:0xf bank_mask:0xf
    v_add_f32_dpp v172, v174, v172 row_shl:8 row_mask:0xf bank_mask:0xf
    v_add_f32_dpp v160, v163, v160 row_shl:12 row_mask:0xf bank_mask:0xf
    v_add_f32_dpp v164, v167, v164 row_shl:12 row_mask:0xf bank_mask:0xf
    v_add_f32_dpp v168, v171, v168 row_shl:12 row_mask:0xf bank_mask:0xf
    v_add_f32_dpp v172, v175, v172 row_shl:12 row_mask:0xf bank_mask:0xf
    v_mfma_f32_16x16x32_bf16 v[192:195], v[208:211], v[12:15], 0
    v_mfma_f32_16x16x32_bf16 v[196:199], v[212:215], v[12:15], 0
    v_mfma_f32_16x16x32_bf16 v[200:203], v[216:219], v[12:15], 0
    v_mfma_f32_16x16x32_bf16 v[204:207], v[220:223], v[12:15], 0
    v_add_f32_dpp v176, v177, v176 row_shl:4 row_mask:0xf bank_mask:0xf
    v_add_f32_dpp v180, v181, v180 row_shl:4 row_mask:0xf bank_mask:0xf
    v_add_f32_dpp v184, v185, v184 row_shl:4 row_mask:0xf bank_mask:0xf
    v_add_f32_dpp v188, v189, v188 row_shl:4 row_mask:0xf bank_mask:0xf
    v_add_f32_dpp v176, v178, v176 row_shl:8 row_mask:0xf bank_mask:0xf
    v_add_f32_dpp v180, v182, v180 row_shl:8 row_mask:0xf bank_mask:0xf
    v_add_f32_dpp v184, v186, v184 row_shl:8 row_mask:0xf bank_mask:0xf
    v_add_f32_dpp v188, v190, v188 row_shl:8 row_mask:0xf bank_mask:0xf
    v_add_f32_dpp v176, v179, v176 row_shl:12 row_mask:0xf bank_mask:0xf
    v_add_f32_dpp v180, v183, v180 row_shl:12 row_mask:0xf bank_mask:0xf
    v_add_f32_dpp v184, v187, v184 row_shl:12 row_mask:0xf bank_mask:0xf
    v_add_f32_dpp v188, v191, v188 row_shl:12 row_mask:0xf bank_mask:0xf
    s_cmp_gt_u32 s92, 0
    s_cselect_b64 vcc, -1, 0
    v_cndmask_b32 v176, v4, v176, vcc
    s_cmp_gt_u32 s92, 1
    s_cselect_b64 vcc, -1, 0
    v_cndmask_b32 v180, v4, v180, vcc
    s_cmp_gt_u32 s92, 2
    s_cselect_b64 vcc, -1, 0
    v_cndmask_b32 v184, v4, v184, vcc
    s_cmp_gt_u32 s92, 3
    s_cselect_b64 vcc, -1, 0
    v_cndmask_b32 v188, v4, v188, vcc
    v_mfma_f32_16x16x32_bf16 v[208:211], v[224:227], v[12:15], 0
    v_mfma_f32_16x16x32_bf16 v[212:215], v[228:231], v[12:15], 0
    v_mfma_f32_16x16x32_bf16 v[216:219], v[232:235], v[12:15], 0
    v_mfma_f32_16x16x32_bf16 v[220:223], v[236:239], v[12:15], 0
    v_add_f32_dpp v192, v193, v192 row_shl:4 row_mask:0xf bank_mask:0xf
    v_add_f32_dpp v196, v197, v196 row_shl:4 row_mask:0xf bank_mask:0xf
    v_add_f32_dpp v200, v201, v200 row_shl:4 row_mask:0xf bank_mask:0xf
    v_add_f32_dpp v204, v205, v204 row_shl:4 row_mask:0xf bank_mask:0xf
    v_add_f32_dpp v192, v194, v192 row_shl:8 row_mask:0xf bank_mask:0xf
    v_add_f32_dpp v196, v198, v196 row_shl:8 row_mask:0xf bank_mask:0xf
    v_add_f32_dpp v200, v202, v200 row_shl:8 row_mask:0xf bank_mask:0xf
    v_add_f32_dpp v204, v206, v204 row_shl:8 row_mask:0xf bank_mask:0xf
    v_add_f32_dpp v192, v195, v192 row_shl:12 row_mask:0xf bank_mask:0xf
    v_add_f32_dpp v196, v199, v196 row_shl:12 row_mask:0xf bank_mask:0xf
    v_add_f32_dpp v200, v203, v200 row_shl:12 row_mask:0xf bank_mask:0xf
    v_add_f32_dpp v204, v207, v204 row_shl:12 row_mask:0xf bank_mask:0xf
    s_cmp_gt_u32 s92, 4
    s_cselect_b64 vcc, -1, 0
    v_cndmask_b32 v192, v4, v192, vcc
    s_cmp_gt_u32 s92, 5
    s_cselect_b64 vcc, -1, 0
    v_cndmask_b32 v196, v4, v196, vcc
    s_cmp_gt_u32 s92, 6
    s_cselect_b64 vcc, -1, 0
    v_cndmask_b32 v200, v4, v200, vcc
    s_cmp_gt_u32 s92, 7
    s_cselect_b64 vcc, -1, 0
    v_cndmask_b32 v204, v4, v204, vcc
    v_add_f32_dpp v208, v209, v208 row_shl:4 row_mask:0xf bank_mask:0xf
    v_add_f32_dpp v212, v213, v212 row_shl:4 row_mask:0xf bank_mask:0xf
    v_add_f32_dpp v216, v217, v216 row_shl:4 row_mask:0xf bank_mask:0xf
    v_add_f32_dpp v220, v221, v220 row_shl:4 row_mask:0xf bank_mask:0xf
    v_add_f32_dpp v208, v210, v208 row_shl:8 row_mask:0xf bank_mask:0xf
    v_add_f32_dpp v212, v214, v212 row_shl:8 row_mask:0xf bank_mask:0xf
    v_add_f32_dpp v216, v218, v216 row_shl:8 row_mask:0xf bank_mask:0xf
    v_add_f32_dpp v220, v222, v220 row_shl:8 row_mask:0xf bank_mask:0xf
    v_add_f32_dpp v208, v211, v208 row_shl:12 row_mask:0xf bank_mask:0xf
    v_add_f32_dpp v212, v215, v212 row_shl:12 row_mask:0xf bank_mask:0xf
    v_add_f32_dpp v216, v219, v216 row_shl:12 row_mask:0xf bank_mask:0xf
    v_add_f32_dpp v220, v223, v220 row_shl:12 row_mask:0xf bank_mask:0xf
    s_cmp_gt_u32 s92, 8
    s_cselect_b64 vcc, -1, 0
    v_cndmask_b32 v208, v4, v208, vcc
    s_cmp_gt_u32 s92, 9
    s_cselect_b64 vcc, -1, 0
    v_cndmask_b32 v212, v4, v212, vcc
    s_cmp_gt_u32 s92, 10
    s_cselect_b64 vcc, -1, 0
    v_cndmask_b32 v216, v4, v216, vcc
    s_cmp_gt_u32 s92, 11
    s_cselect_b64 vcc, -1, 0
    v_cndmask_b32 v220, v4, v220, vcc
    v_max3_f32 v9, v16, v20, v24
    v_max3_f32 v3, v28, v96, v100
    v_max3_f32 v9, v104, v108, v9
    v_max3_f32 v3, v112, v116, v3
    v_max3_f32 v9, v120, v124, v9
    v_max3_f32 v3, v128, v132, v3
    v_max3_f32 v9, v136, v140, v9
    v_max3_f32 v3, v144, v148, v3
    v_max3_f32 v9, v152, v156, v9
    v_max3_f32 v3, v160, v164, v3
    v_max3_f32 v9, v168, v172, v9
    v_max3_f32 v3, v176, v180, v3
    v_max3_f32 v9, v184, v188, v9
    v_max3_f32 v3, v192, v196, v3
    v_max3_f32 v9, v200, v204, v9
    v_max3_f32 v3, v208, v212, v3
    v_max3_f32 v9, v216, v220, v9
    v_max_f32 v9, v9, v3
    v_mov_b32 v3, v9
    s_nop 1
    v_permlane16_swap_b32 v9, v3
    v_max_f32 v9, v9, v3
    v_mov_b32 v3, v9
    s_nop 1
    v_permlane32_swap_b32 v9, v3
    v_max_f32 v9, v9, v3
    v_mul_f32 v9, s82, v9
    v_fma_f32 v16, v16, s82, -v9
    v_fma_f32 v20, v20, s82, -v9
    v_fma_f32 v24, v24, s82, -v9
    v_fma_f32 v28, v28, s82, -v9
    v_fma_f32 v96, v96, s82, -v9
    v_fma_f32 v100, v100, s82, -v9
    v_fma_f32 v104, v104, s82, -v9
    v_fma_f32 v108, v108, s82, -v9
    v_fma_f32 v112, v112, s82, -v9
    v_fma_f32 v116, v116, s82, -v9
    v_fma_f32 v120, v120, s82, -v9
    v_fma_f32 v124, v124, s82, -v9
    v_fma_f32 v128, v128, s82, -v9
    v_fma_f32 v132, v132, s82, -v9
    v_fma_f32 v136, v136, s82, -v9
    v_fma_f32 v140, v140, s82, -v9
    v_fma_f32 v144, v144, s82, -v9
    v_fma_f32 v148, v148, s82, -v9
    v_fma_f32 v152, v152, s82, -v9
    v_fma_f32 v156, v156, s82, -v9
    v_fma_f32 v160, v160, s82, -v9
    v_fma_f32 v164, v164, s82, -v9
    v_fma_f32 v168, v168, s82, -v9
    v_fma_f32 v172, v172, s82, -v9
    v_fma_f32 v176, v176, s82, -v9
    v_fma_f32 v180, v180, s82, -v9
    v_fma_f32 v184, v184, s82, -v9
    v_fma_f32 v188, v188, s82, -v9
    v_fma_f32 v192, v192, s82, -v9
    v_fma_f32 v196, v196, s82, -v9
    v_fma_f32 v200, v200, s82, -v9
    v_fma_f32 v204, v204, s82, -v9
    v_fma_f32 v208, v208, s82, -v9
    v_fma_f32 v212, v212, s82, -v9
    v_fma_f32 v216, v216, s82, -v9
    v_fma_f32 v220, v220, s82, -v9
    v_exp_f32 v16, v16
    v_exp_f32 v20, v20
    v_exp_f32 v24, v24
    v_exp_f32 v28, v28
    v_exp_f32 v96, v96
    v_exp_f32 v100, v100
    v_exp_f32 v104, v104
    v_exp_f32 v108, v108
    v_exp_f32 v112, v112
    v_exp_f32 v116, v116
    v_exp_f32 v120, v120
    v_exp_f32 v124, v124
    v_exp_f32 v128, v128
    v_exp_f32 v132, v132
    v_exp_f32 v136, v136
    v_exp_f32 v140, v140
    v_exp_f32 v144, v144
    v_exp_f32 v148, v148
    v_exp_f32 v152, v152
    v_exp_f32 v156, v156
    v_exp_f32 v160, v160
    v_exp_f32 v164, v164
    v_exp_f32 v168, v168
    v_exp_f32 v172, v172
    v_exp_f32 v176, v176
    v_exp_f32 v180, v180
    v_exp_f32 v184, v184
    v_exp_f32 v188, v188
    v_exp_f32 v192, v192
    v_exp_f32 v196, v196
    v_exp_f32 v200, v200
    v_exp_f32 v204, v204
    v_exp_f32 v208, v208
    v_exp_f32 v212, v212
    v_exp_f32 v216, v216
    v_exp_f32 v220, v220
    v_add_f32 v10, v16, v20
    v_add_f32 v3, v24, v28
    v_add_f32 v10, v10, v96
    v_add_f32 v3, v3, v100
    v_add_f32 v10, v10, v104
    v_add_f32 v3, v3, v108
    v_add_f32 v10, v10, v112
    v_add_f32 v3, v3, v116
    v_add_f32 v10, v10, v120
    v_add_f32 v3, v3, v124
    v_add_f32 v10, v10, v128
    v_add_f32 v3, v3, v132
    v_add_f32 v10, v10, v136
    v_add_f32 v3, v3, v140
    v_add_f32 v10, v10, v144
    v_add_f32 v3, v3, v148
    v_add_f32 v10, v10, v152
    v_add_f32 v3, v3, v156
    v_add_f32 v10, v10, v160
    v_add_f32 v3, v3, v164
    v_add_f32 v10, v10, v168
    v_add_f32 v3, v3, v172
    v_add_f32 v10, v10, v176
    v_add_f32 v3, v3, v180
    v_add_f32 v10, v10, v184
    v_add_f32 v3, v3, v188
    v_add_f32 v10, v10, v192
    v_add_f32 v3, v3, v196
    v_add_f32 v10, v10, v200
    v_add_f32 v3, v3, v204
    v_add_f32 v10, v10, v208
    v_add_f32 v3, v3, v212
    v_add_f32 v10, v10, v216
    v_add_f32 v3, v3, v220
    v_add_f32 v10, v10, v3
    v_cvt_pk_bf16_f32 v224, v16, v20
    v_cvt_pk_bf16_f32 v225, v24, v28
    v_cvt_pk_bf16_f32 v226, v96, v100
    v_cvt_pk_bf16_f32 v227, v104, v108
    v_cvt_pk_bf16_f32 v228, v112, v116
    v_cvt_pk_bf16_f32 v229, v120, v124
    v_cvt_pk_bf16_f32 v230, v128, v132
    v_cvt_pk_bf16_f32 v231, v136, v140
    v_cvt_pk_bf16_f32 v232, v144, v148
    v_cvt_pk_bf16_f32 v233, v152, v156
    v_cvt_pk_bf16_f32 v234, v160, v164
    v_cvt_pk_bf16_f32 v235, v168, v172
    v_cvt_pk_bf16_f32 v236, v176, v180
    v_cvt_pk_bf16_f32 v237, v184, v188
    v_cvt_pk_bf16_f32 v238, v192, v196
    v_cvt_pk_bf16_f32 v239, v200, v204
    v_cvt_pk_bf16_f32 v12, v208, v212
    v_cvt_pk_bf16_f32 v13, v216, v220
    v_mov_b32 v3, v10
    s_nop 1
    v_permlane16_swap_b32 v10, v3
    v_add_f32 v10, v10, v3
    v_mov_b32 v3, v10
    s_nop 1
    v_permlane32_swap_b32 v10, v3
    v_add_f32 v10, v10, v3
    s_lshl_b32 s72, s64, 5
    s_add_u32 s72, s72, 121088
    v_lshl_add_u32 v3, v0, 2, s72
    s_mov_b64 exec, 15
    ds_write2_b32 v3, v9, v10 offset0:0 offset1:4
    v_mov_b32 v4, 121344
    v_mov_b32 v5, 1
    s_waitcnt lgkmcnt(0)
    s_mov_b64 exec, 1
    ds_add_rtn_u32 v6, v4, v5
    s_mov_b64 exec, -1
    v_and_b32 v4, 3, v0
    v_lshl_add_u32 v5, v4, 2, s72
    ds_read_b32 v9, v5
    s_waitcnt lgkmcnt(0)
    v_readfirstlane_b32 s73, v6
    s_nop 0
    s_cmp_eq_u32 s73, 7
    s_cbranch_scc0 L_ml_done
    v_bfe_u32 v5, v0, 2, 3
    v_lshlrev_b32 v5, 5, v5
    v_lshl_add_u32 v5, v4, 2, v5
    v_add_u32 v5, 121088, v5
    ds_read2_b32 v[6:7], v5 offset0:0 offset1:4
    s_waitcnt lgkmcnt(0)
    v_max_f32_dpp v8, v6, v6 row_ror:4 row_mask:0xf bank_mask:0xf
    s_nop 1
    v_max_f32_dpp v8, v8, v8 row_ror:8 row_mask:0xf bank_mask:0xf
    v_mov_b32 v5, v8
    s_nop 1
    v_permlane16_swap_b32 v8, v5
    v_max_f32 v8, v8, v5
    v_sub_f32 v6, v6, v8
    v_exp_f32 v6, v6
    s_nop 0
    v_mul_f32 v7, v7, v6
    s_nop 1
    v_add_f32_dpp v7, v7, v7 row_ror:4 row_mask:0xf bank_mask:0xf
    s_nop 1
    v_add_f32_dpp v7, v7, v7 row_ror:8 row_mask:0xf bank_mask:0xf
    v_mov_b32 v5, v7
    s_nop 1
    v_permlane16_swap_b32 v7, v5
    v_add_f32 v7, v7, v5
    v_mov_b32 v6, v8
    v_mov_b32 v8, v7
    v_mov_b32 v7, s95
    v_mov_b32 v5, s95
    s_lshl_b32 s72, s62, 3
    s_add_u32 s72, s72, s60
    s_lshl_b32 s72, s72, 3
    s_add_u32 s72, s72, s63
    s_lshl_b32 s72, s72, 6
    s_add_u32 s72, s72, 65536
    v_lshlrev_b32 v4, 4, v4
    v_mov_b32 v16, v6
    v_mov_b32 v17, v7
    v_mov_b32 v18, v8
    v_mov_b32 v19, v5
    s_mov_b64 exec, 15
    s_cmp_eq_u32 s69, 0
    s_cbranch_scc1 L_st_16_slow
    buffer_store_dwordx4 v[16:19], v4, s[40:43], s72 offen
L_st_16_done:
    s_mov_b64 exec, -1
L_ml_done:
    s_cmp_ge_u32 s64, 4
    s_cbranch_scc1 L_ti
    s_cmp_eq_u32 s65, 4
    s_cbranch_scc1 L_ti_go
    s_cmp_eq_u32 s65, 1
    s_cbranch_scc0 L_ti
    s_cmp_eq_u32 s64, 3
    s_cbranch_scc0 L_ti
L_ti_go:
    s_mov_b32 s56, s4
    s_mov_b32 s57, s5
    s_mov_b32 s58, 4096
    s_mov_b32 s59, 0x00020000
    s_mul_i32 s73, s64, 6144
    s_add_u32 s73, s73, 2048
    s_lshl_b32 s72, s64, 10
    s_cmp_eq_u32 s65, 1
    s_cbranch_scc1 L_ti_r
    buffer_load_dwordx4 v[24:27], v2, s[56:59], s72 offen
    buffer_load_dwordx4 v[28:31], v2, s[40:43], s73 offen offset:0 sc1
    buffer_load_dwordx4 v[244:247], v2, s[40:43], s73 offen offset:1024 sc1
    buffer_load_dwordx4 v[248:251], v2, s[40:43], s73 offen offset:2048 sc1
    s_branch L_ti
L_ti_r:
    s_and_b32 s79, s66, 3
    s_lshr_b32 s76, s66, 2
    s_lshl_b32 s72, s60, 1
    s_add_u32 s76, s76, s72
    s_lshl_b32 s76, s76, 5
    v_and_b32 v3, 7, v0
    v_lshlrev_b32 v3, 2, v3
    v_lshrrev_b32 v4, 5, v0
    v_lshl_add_u32 v3, v4, 1, v3
    v_add_u32 v3, s76, v3
    v_lshlrev_b32 v5, 1, v3
    s_mul_i32 s73, s79, 6144
    s_add_u32 s73, s73, 2048
    s_lshl_b32 s72, s79, 10
    buffer_load_dword v24, v5, s[56:59], s72 offen
    buffer_load_dword v25, v5, s[40:43], s73 offen sc1
    buffer_load_dword v26, v5, s[40:43], s73 offen offset:3072 sc1
L_ti:
    v_and_b32 v241, 31, v0
    v_lshlrev_b32 v241, 4, v241
    s_lshl_b32 s77, s62, 3
    s_add_u32 s77, s77, s60
    s_lshl_b32 s77, s77, 9
    s_add_u32 s77, s77, 65536
    v_bfe_u32 v3, v0, 3, 2
    v_lshlrev_b32 v3, 12, v3
    v_and_b32 v4, 7, v0
    v_lshl_add_u32 v3, v4, 6, v3
    s_lshl_b32 s72, s60, 9
    s_add_u32 s72, s72, 65540
    v_add_u32 v242, s72, v3
    v_and_b32 v3, 3, v0
    v_mul_u32_u24 v3, 288, v3
    v_lshrrev_b32 v4, 2, v0
    v_lshl_add_u32 v3, v4, 4, v3
    s_mul_i32 s72, s64, 2304
    s_add_u32 s72, s72, 102656
    v_add_u32 v5, s72, v3
    v_bfe_u32 v3, v0, 1, 1
    v_mul_u32_u24 v3, 1152, v3
    v_lshl_add_u32 v3, v4, 4, v3
    v_and_b32 v4, 1, v0
    v_lshl_add_u32 v3, v4, 3, v3
    s_mul_i32 s72, s64, 288
    s_add_u32 s72, s72, 102656
    v_add_u32 v6, s72, v3
    v_and_b32 v7, 3, v0
    v_lshlrev_b32 v7, 2, v7
    v_bfe_u32 v3, v0, 2, 2
    v_lshl_add_u32 v7, v3, 8, v7
    v_bfe_u32 v3, v0, 4, 1
    v_lshl_add_u32 v7, v3, 10, v7
    v_lshrrev_b32 v3, 5, v0
    v_lshl_add_u32 v7, v3, 12, v7
    s_lshl_b32 s76, s60, 15
    s_lshl_b32 s72, s64, 13
    s_add_u32 s76, s76, s72
    s_lshr_b32 s72, s63, 2
    s_lshl_b32 s72, s72, 11
    s_add_u32 s76, s76, s72
    s_and_b32 s72, s63, 3
    s_lshl_b32 s72, s72, 6
    s_add_u32 s76, s76, s72
    s_lshl_b32 s72, s62, 4
    s_add_u32 s76, s76, s72
    s_add_u32 s76, s76, 262144
    s_mov_b32 s84, 0
    s_mov_b32 s85, 131072
    s_waitcnt vmcnt(3)
    buffer_load_dwordx4 v[96:99], v2, s[36:39], s85 offen offset:0 nt
    s_waitcnt vmcnt(3)
    buffer_load_dwordx4 v[100:103], v2, s[36:39], s85 offen offset:1024 nt
    s_waitcnt vmcnt(3)
    buffer_load_dwordx4 v[104:107], v2, s[36:39], s85 offen offset:2048 nt
    s_waitcnt vmcnt(3)
    buffer_load_dwordx4 v[108:111], v2, s[36:39], s85 offen offset:3072 nt
    s_waitcnt vmcnt(17)
    v_perm_b32 v208, v36, v32, s80
    v_perm_b32 v209, v44, v40, s80
    v_perm_b32 v210, v36, v32, s81
    v_perm_b32 v211, v44, v40, s81
    v_mfma_f32_16x16x16_bf16 v[176:179], v[208:209], v[224:225], 0
    v_perm_b32 v212, v37, v33, s80
    v_perm_b32 v213, v45, v41, s80
    v_mfma_f32_16x16x16_bf16 v[180:183], v[210:211], v[224:225], 0
    v_perm_b32 v214, v37, v33, s81
    v_perm_b32 v215, v45, v41, s81
    v_mfma_f32_16x16x16_bf16 v[184:187], v[212:213], v[224:225], 0
    v_perm_b32 v216, v38, v34, s80
    v_perm_b32 v217, v46, v42, s80
    v_mfma_f32_16x16x16_bf16 v[188:191], v[214:215], v[224:225], 0
    v_perm_b32 v218, v38, v34, s81
    v_perm_b32 v219, v46, v42, s81
    v_mfma_f32_16x16x16_bf16 v[192:195], v[216:217], v[224:225], 0
    v_perm_b32 v220, v39, v35, s80
    v_perm_b32 v221, v47, v43, s80
    v_mfma_f32_16x16x16_bf16 v[196:199], v[218:219], v[224:225], 0
    v_perm_b32 v222, v39, v35, s81
    v_perm_b32 v223, v47, v43, s81
    v_mfma_f32_16x16x16_bf16 v[200:203], v[220:221], v[224:225], 0
    s_nop 0
    v_mfma_f32_16x16x16_bf16 v[204:207], v[222:223], v[224:225], 0
    s_cmp_le_u32 s92, 0
    s_cbranch_scc0 L_mlq_17
    buffer_load_dwordx4 v[20:23], v241, s[40:43], s77 offen sc1
    buffer_load_dword v15, v242, s[40:43], 0 offen sc1
L_mlq_17:
    s_mov_b32 s85, 163840
    s_waitcnt vmcnt(3)
    buffer_load_dwordx4 v[112:115], v2, s[36:39], s85 offen offset:0 nt
    s_waitcnt vmcnt(14)
    v_perm_b32 v208, v52, v48, s80
    v_perm_b32 v209, v60, v56, s80
    v_perm_b32 v210, v52, v48, s81
    v_perm_b32 v211, v60, v56, s81
    v_mfma_f32_16x16x16_bf16 v[176:179], v[208:209], v[226:227], v[176:179]
    v_perm_b32 v212, v53, v49, s80
    v_perm_b32 v213, v61, v57, s80
    v_mfma_f32_16x16x16_bf16 v[180:183], v[210:211], v[226:227], v[180:183]
    v_perm_b32 v214, v53, v49, s81
    v_perm_b32 v215, v61, v57, s81
    v_mfma_f32_16x16x16_bf16 v[184:187], v[212:213], v[226:227], v[184:187]
    v_perm_b32 v216, v54, v50, s80
    v_perm_b32 v217, v62, v58, s80
    v_mfma_f32_16x16x16_bf16 v[188:191], v[214:215], v[226:227], v[188:191]
    v_perm_b32 v218, v54, v50, s81
    v_perm_b32 v219, v62, v58, s81
    v_mfma_f32_16x16x16_bf16 v[192:195], v[216:217], v[226:227], v[192:195]
    v_perm_b32 v220, v55, v51, s80
    v_perm_b32 v221, v63, v59, s80
    v_mfma_f32_16x16x16_bf16 v[196:199], v[218:219], v[226:227], v[196:199]
    v_perm_b32 v222, v55, v51, s81
    v_perm_b32 v223, v63, v59, s81
    v_mfma_f32_16x16x16_bf16 v[200:203], v[220:221], v[226:227], v[200:203]
    s_nop 0
    v_mfma_f32_16x16x16_bf16 v[204:207], v[222:223], v[226:227], v[204:207]
    s_waitcnt vmcnt(3)
    buffer_load_dwordx4 v[116:119], v2, s[36:39], s85 offen offset:1024 nt
    s_waitcnt vmcnt(10)
    v_perm_b32 v208, v68, v64, s80
    v_perm_b32 v209, v76, v72, s80
    v_perm_b32 v210, v68, v64, s81
    v_perm_b32 v211, v76, v72, s81
    v_mfma_f32_16x16x16_bf16 v[176:179], v[208:209], v[228:229], v[176:179]
    v_perm_b32 v212, v69, v65, s80
    v_perm_b32 v213, v77, v73, s80
    v_mfma_f32_16x16x16_bf16 v[180:183], v[210:211], v[228:229], v[180:183]
    v_perm_b32 v214, v69, v65, s81
    v_perm_b32 v215, v77, v73, s81
    v_mfma_f32_16x16x16_bf16 v[184:187], v[212:213], v[228:229], v[184:187]
    v_perm_b32 v216, v70, v66, s80
    v_perm_b32 v217, v78, v74, s80
    v_mfma_f32_16x16x16_bf16 v[188:191], v[214:215], v[228:229], v[188:191]
    v_perm_b32 v218, v70, v66, s81
    v_perm_b32 v219, v78, v74, s81
    v_mfma_f32_16x16x16_bf16 v[192:195], v[216:217], v[228:229], v[192:195]
    v_perm_b32 v220, v71, v67, s80
    v_perm_b32 v221, v79, v75, s80
    v_mfma_f32_16x16x16_bf16 v[196:199], v[218:219], v[228:229], v[196:199]
    v_perm_b32 v222, v71, v67, s81
    v_perm_b32 v223, v79, v75, s81
    v_mfma_f32_16x16x16_bf16 v[200:203], v[220:221], v[228:229], v[200:203]
    s_nop 0
    v_mfma_f32_16x16x16_bf16 v[204:207], v[222:223], v[228:229], v[204:207]
    s_waitcnt vmcnt(3)
    buffer_load_dwordx4 v[120:123], v2, s[36:39], s85 offen offset:2048 nt
    s_waitcnt vmcnt(7)
    v_perm_b32 v208, v84, v80, s80
    v_perm_b32 v209, v92, v88, s80
    v_perm_b32 v210, v84, v80, s81
    v_perm_b32 v211, v92, v88, s81
    v_mfma_f32_16x16x16_bf16 v[176:179], v[208:209], v[230:231], v[176:179]
    v_perm_b32 v212, v85, v81, s80
    v_perm_b32 v213, v93, v89, s80
    v_mfma_f32_16x16x16_bf16 v[180:183], v[210:211], v[230:231], v[180:183]
    v_perm_b32 v214, v85, v81, s81
    v_perm_b32 v215, v93, v89, s81
    v_mfma_f32_16x16x16_bf16 v[184:187], v[212:213], v[230:231], v[184:187]
    v_perm_b32 v216, v86, v82, s80
    v_perm_b32 v217, v94, v90, s80
    v_mfma_f32_16x16x16_bf16 v[188:191], v[214:215], v[230:231], v[188:191]
    v_perm_b32 v218, v86, v82, s81
    v_perm_b32 v219, v94, v90, s81
    v_mfma_f32_16x16x16_bf16 v[192:195], v[216:217], v[230:231], v[192:195]
    v_perm_b32 v220, v87, v83, s80
    v_perm_b32 v221, v95, v91, s80
    v_mfma_f32_16x16x16_bf16 v[196:199], v[218:219], v[230:231], v[196:199]
    v_perm_b32 v222, v87, v83, s81
    v_perm_b32 v223, v95, v91, s81
    v_mfma_f32_16x16x16_bf16 v[200:203], v[220:221], v[230:231], v[200:203]
    s_nop 0
    v_mfma_f32_16x16x16_bf16 v[204:207], v[222:223], v[230:231], v[204:207]
    s_waitcnt vmcnt(3)
    buffer_load_dwordx4 v[124:127], v2, s[36:39], s85 offen offset:3072 nt
    s_cmp_le_u32 s92, 0
    s_cbranch_scc1 L_vexit5
    s_cmp_le_u32 s92, 4
    s_cbranch_scc0 L_mlq_18
    buffer_load_dwordx4 v[20:23], v241, s[40:43], s77 offen sc1
    buffer_load_dword v15, v242, s[40:43], 0 offen sc1
L_mlq_18:
    s_waitcnt vmcnt(3)
    buffer_load_dwordx4 v[128:131], v2, s[36:39], s88 offen offset:0 nt
    s_waitcnt vmcnt(3)
    buffer_load_dwordx4 v[132:135], v2, s[36:39], s88 offen offset:1024 nt
    s_waitcnt vmcnt(3)
    buffer_load_dwordx4 v[136:139], v2, s[36:39], s88 offen offset:2048 nt
    s_waitcnt vmcnt(3)
    buffer_load_dwordx4 v[140:143], v2, s[36:39], s88 offen offset:3072 nt
    s_waitcnt vmcnt(8)
    v_perm_b32 v208, v100, v96, s80
    v_perm_b32 v209, v108, v104, s80
    v_perm_b32 v210, v100, v96, s81
    v_perm_b32 v211, v108, v104, s81
    v_mfma_f32_16x16x16_bf16 v[176:179], v[208:209], v[232:233], v[176:179]
    v_perm_b32 v212, v101, v97, s80
    v_perm_b32 v213, v109, v105, s80
    v_mfma_f32_16x16x16_bf16 v[180:183], v[210:211], v[232:233], v[180:183]
    v_perm_b32 v214, v101, v97, s81
    v_perm_b32 v215, v109, v105, s81
    v_mfma_f32_16x16x16_bf16 v[184:187], v[212:213], v[232:233], v[184:187]
    v_perm_b32 v216, v102, v98, s80
    v_perm_b32 v217, v110, v106, s80
    v_mfma_f32_16x16x16_bf16 v[188:191], v[214:215], v[232:233], v[188:191]
    v_perm_b32 v218, v102, v98, s81
    v_perm_b32 v219, v110, v106, s81
    v_mfma_f32_16x16x16_bf16 v[192:195], v[216:217], v[232:233], v[192:195]
    v_perm_b32 v220, v103, v99, s80
    v_perm_b32 v221, v111, v107, s80
    v_mfma_f32_16x16x16_bf16 v[196:199], v[218:219], v[232:233], v[196:199]
    v_perm_b32 v222, v103, v99, s81
    v_perm_b32 v223, v111, v107, s81
    v_mfma_f32_16x16x16_bf16 v[200:203], v[220:221], v[232:233], v[200:203]
    s_nop 0
    v_mfma_f32_16x16x16_bf16 v[204:207], v[222:223], v[232:233], v[204:207]
    s_cmp_le_u32 s92, 4
    s_cbranch_scc1 L_vexit6
    s_cmp_le_u32 s92, 8
    s_cbranch_scc0 L_mlq_19
    buffer_load_dwordx4 v[20:23], v241, s[40:43], s77 offen sc1
    buffer_load_dword v15, v242, s[40:43], 0 offen sc1
L_mlq_19:
    s_waitcnt vmcnt(7)
    buffer_load_dwordx4 v[144:147], v2, s[36:39], s89 offen offset:0 nt
    s_waitcnt vmcnt(7)
    buffer_load_dwordx4 v[148:151], v2, s[36:39], s89 offen offset:1024 nt
    s_waitcnt vmcnt(7)
    buffer_load_dwordx4 v[152:155], v2, s[36:39], s89 offen offset:2048 nt
    s_waitcnt vmcnt(7)
    buffer_load_dwordx4 v[156:159], v2, s[36:39], s89 offen offset:3072 nt
    s_waitcnt vmcnt(8)
    v_perm_b32 v208, v116, v112, s80
    v_perm_b32 v209, v124, v120, s80
    v_perm_b32 v210, v116, v112, s81
    v_perm_b32 v211, v124, v120, s81
    v_mfma_f32_16x16x16_bf16 v[176:179], v[208:209], v[234:235], v[176:179]
    v_perm_b32 v212, v117, v113, s80
    v_perm_b32 v213, v125, v121, s80
    v_mfma_f32_16x16x16_bf16 v[180:183], v[210:211], v[234:235], v[180:183]
    v_perm_b32 v214, v117, v113, s81
    v_perm_b32 v215, v125, v121, s81
    v_mfma_f32_16x16x16_bf16 v[184:187], v[212:213], v[234:235], v[184:187]
    v_perm_b32 v216, v118, v114, s80
    v_perm_b32 v217, v126, v122, s80
    v_mfma_f32_16x16x16_bf16 v[188:191], v[214:215], v[234:235], v[188:191]
    v_perm_b32 v218, v118, v114, s81
    v_perm_b32 v219, v126, v122, s81
    v_mfma_f32_16x16x16_bf16 v[192:195], v[216:217], v[234:235], v[192:195]
    v_perm_b32 v220, v119, v115, s80
    v_perm_b32 v221, v127, v123, s80
    v_mfma_f32_16x16x16_bf16 v[196:199], v[218:219], v[234:235], v[196:199]
    v_perm_b32 v222, v119, v115, s81
    v_perm_b32 v223, v127, v123, s81
    v_mfma_f32_16x16x16_bf16 v[200:203], v[220:221], v[234:235], v[200:203]
    s_nop 0
    v_mfma_f32_16x16x16_bf16 v[204:207], v[222:223], v[234:235], v[204:207]
    s_cmp_le_u32 s92, 8
    s_cbranch_scc1 L_vexit7
    buffer_load_dwordx4 v[20:23], v241, s[40:43], s77 offen sc1
    buffer_load_dword v15, v242, s[40:43], 0 offen sc1
L_mlq_20:
    s_waitcnt vmcnt(7)
    buffer_load_dwordx4 v[160:163], v2, s[36:39], s90 offen offset:0 nt
    s_waitcnt vmcnt(7)
    buffer_load_dwordx4 v[164:167], v2, s[36:39], s90 offen offset:1024 nt
    s_waitcnt vmcnt(7)
    buffer_load_dwordx4 v[168:171], v2, s[36:39], s90 offen offset:2048 nt
    s_waitcnt vmcnt(7)
    buffer_load_dwordx4 v[172:175], v2, s[36:39], s90 offen offset:3072 nt
    s_waitcnt vmcnt(8)
    v_perm_b32 v208, v132, v128, s80
    v_perm_b32 v209, v140, v136, s80
    v_perm_b32 v210, v132, v128, s81
    v_perm_b32 v211, v140, v136, s81
    v_mfma_f32_16x16x16_bf16 v[176:179], v[208:209], v[236:237], v[176:179]
    v_perm_b32 v212, v133, v129, s80
    v_perm_b32 v213, v141, v137, s80
    v_mfma_f32_16x16x16_bf16 v[180:183], v[210:211], v[236:237], v[180:183]
    v_perm_b32 v214, v133, v129, s81
    v_perm_b32 v215, v141, v137, s81
    v_mfma_f32_16x16x16_bf16 v[184:187], v[212:213], v[236:237], v[184:187]
    v_perm_b32 v216, v134, v130, s80
    v_perm_b32 v217, v142, v138, s80
    v_mfma_f32_16x16x16_bf16 v[188:191], v[214:215], v[236:237], v[188:191]
    v_perm_b32 v218, v134, v130, s81
    v_perm_b32 v219, v142, v138, s81
    v_mfma_f32_16x16x16_bf16 v[192:195], v[216:217], v[236:237], v[192:195]
    v_perm_b32 v220, v135, v131, s80
    v_perm_b32 v221, v143, v139, s80
    v_mfma_f32_16x16x16_bf16 v[196:199], v[218:219], v[236:237], v[196:199]
    v_perm_b32 v222, v135, v131, s81
    v_perm_b32 v223, v143, v139, s81
    v_mfma_f32_16x16x16_bf16 v[200:203], v[220:221], v[236:237], v[200:203]
    s_nop 0
    v_mfma_f32_16x16x16_bf16 v[204:207], v[222:223], v[236:237], v[204:207]
    s_waitcnt vmcnt(4)
    v_perm_b32 v208, v148, v144, s80
    v_perm_b32 v209, v156, v152, s80
    v_perm_b32 v210, v148, v144, s81
    v_perm_b32 v211, v156, v152, s81
    v_mfma_f32_16x16x16_bf16 v[176:179], v[208:209], v[238:239], v[176:179]
    v_perm_b32 v212, v149, v145, s80
    v_perm_b32 v213, v157, v153, s80
    v_mfma_f32_16x16x16_bf16 v[180:183], v[210:211], v[238:239], v[180:183]
    v_perm_b32 v214, v149, v145, s81
    v_perm_b32 v215, v157, v153, s81
    v_mfma_f32_16x16x16_bf16 v[184:187], v[212:213], v[238:239], v[184:187]
    v_perm_b32 v216, v150, v146, s80
    v_perm_b32 v217, v158, v154, s80
    v_mfma_f32_16x16x16_bf16 v[188:191], v[214:215], v[238:239], v[188:191]
    v_perm_b32 v218, v150, v146, s81
    v_perm_b32 v219, v158, v154, s81
    v_mfma_f32_16x16x16_bf16 v[192:195], v[216:217], v[238:239], v[192:195]
    v_perm_b32 v220, v151, v147, s80
    v_perm_b32 v221, v159, v155, s80
    v_mfma_f32_16x16x16_bf16 v[196:199], v[218:219], v[238:239], v[196:199]
    v_perm_b32 v222, v151, v147, s81
    v_perm_b32 v223, v159, v155, s81
    v_mfma_f32_16x16x16_bf16 v[200:203], v[220:221], v[238:239], v[200:203]
    s_nop 0
    v_mfma_f32_16x16x16_bf16 v[204:207], v[222:223], v[238:239], v[204:207]
    s_waitcnt vmcnt(4)
    v_xor_b32 v3, s95, v21
    v_bitop3_b32 v3, v3, v23, s95 bitop3:0xf6
    v_bitop3_b32 v3, v3, v15, s95 bitop3:0xf6
    v_cmp_ne_u32 vcc, 0, v3
    s_cbranch_vccnz L_vx_21_late
    v_max_f32_dpp v10, v20, v20 row_ror:4 row_mask:0xf bank_mask:0xf
    s_nop 1
    v_max_f32_dpp v10, v10, v10 row_ror:8 row_mask:0xf bank_mask:0xf
    v_mov_b32 v3, v10
    s_nop 1
    v_permlane16_swap_b32 v10, v3
    v_max_f32 v10, v10, v3
    v_sub_f32 v20, v20, v10
    v_exp_f32 v20, v20
    s_nop 0
    v_mul_f32 v22, v22, v20
    s_nop 1
    v_add_f32_dpp v22, v22, v22 row_ror:4 row_mask:0xf bank_mask:0xf
    s_nop 1
    v_add_f32_dpp v22, v22, v22 row_ror:8 row_mask:0xf bank_mask:0xf
    v_mov_b32 v3, v22
    s_nop 1
    v_permlane16_swap_b32 v22, v3
    v_add_f32 v22, v22, v3
    v_sub_f32 v11, v9, v10
    v_exp_f32 v11, v11
    v_rcp_f32 v22, v22
    s_nop 0
    v_mul_f32 v11, v11, v22
L_vx_21_go:
    s_waitcnt vmcnt(0)
    v_perm_b32 v208, v164, v160, s80
    v_perm_b32 v209, v172, v168, s80
    v_perm_b32 v210, v164, v160, s81
    v_perm_b32 v211, v172, v168, s81
    v_mfma_f32_16x16x16_bf16 v[176:179], v[208:209], v[12:13], v[176:179]
    v_perm_b32 v212, v165, v161, s80
    v_perm_b32 v213, v173, v169, s80
    v_mfma_f32_16x16x16_bf16 v[180:183], v[210:211], v[12:13], v[180:183]
    v_perm_b32 v214, v165, v161, s81
    v_perm_b32 v215, v173, v169, s81
    v_mfma_f32_16x16x16_bf16 v[184:187], v[212:213], v[12:13], v[184:187]
    v_perm_b32 v216, v166, v162, s80
    v_perm_b32 v217, v174, v170, s80
    v_mfma_f32_16x16x16_bf16 v[188:191], v[214:215], v[12:13], v[188:191]
    v_perm_b32 v218, v166, v162, s81
    v_perm_b32 v219, v174, v170, s81
    v_mfma_f32_16x16x16_bf16 v[192:195], v[216:217], v[12:13], v[192:195]
    v_perm_b32 v220, v167, v163, s80
    v_perm_b32 v221, v175, v171, s80
    v_mfma_f32_16x16x16_bf16 v[196:199], v[218:219], v[12:13], v[196:199]
    v_perm_b32 v222, v167, v163, s81
    v_perm_b32 v223, v175, v171, s81
    v_mfma_f32_16x16x16_bf16 v[200:203], v[220:221], v[12:13], v[200:203]
    s_nop 0
    v_mfma_f32_16x16x16_bf16 v[204:207], v[222:223], v[12:13], v[204:207]
L_pv_done:
    s_cmp_eq_u32 s84, 1
    s_cbranch_scc1 L_mlw_spin
L_ml_fin:
    v_mul_f32 v16, v176, v11
    v_mul_f32 v17, v180, v11
    v_mul_f32 v18, v184, v11
    v_mul_f32 v19, v188, v11
    v_mul_f32_dpp v16, v177, v11 row_shr:4 row_mask:0xf bank_mask:0x2
    v_mul_f32_dpp v17, v181, v11 row_shr:4 row_mask:0xf bank_mask:0x2
    v_mul_f32_dpp v18, v185, v11 row_shr:4 row_mask:0xf bank_mask:0x2
    v_mul_f32_dpp v19, v189, v11 row_shr:4 row_mask:0xf bank_mask:0x2
    v_mul_f32_dpp v16, v178, v11 row_shr:8 row_mask:0xf bank_mask:0x4
    v_mul_f32_dpp v17, v182, v11 row_shr:8 row_mask:0xf bank_mask:0x4
    v_mul_f32_dpp v18, v186, v11 row_shr:8 row_mask:0xf bank_mask:0x4
    v_mul_f32_dpp v19, v190, v11 row_shr:8 row_mask:0xf bank_mask:0x4
    v_mul_f32_dpp v16, v179, v11 row_shr:12 row_mask:0xf bank_mask:0x8
    v_mul_f32_dpp v17, v183, v11 row_shr:12 row_mask:0xf bank_mask:0x8
    v_mul_f32_dpp v18, v187, v11 row_shr:12 row_mask:0xf bank_mask:0x8
    v_mul_f32_dpp v19, v191, v11 row_shr:12 row_mask:0xf bank_mask:0x8
    ds_write_b128 v5, v[16:19]
    v_mul_f32 v20, v192, v11
    v_mul_f32 v21, v196, v11
    v_mul_f32 v22, v200, v11
    v_mul_f32 v23, v204, v11
    v_mul_f32_dpp v20, v193, v11 row_shr:4 row_mask:0xf bank_mask:0x2
    v_mul_f32_dpp v21, v197, v11 row_shr:4 row_mask:0xf bank_mask:0x2
    v_mul_f32_dpp v22, v201, v11 row_shr:4 row_mask:0xf bank_mask:0x2
    v_mul_f32_dpp v23, v205, v11 row_shr:4 row_mask:0xf bank_mask:0x2
    v_mul_f32_dpp v20, v194, v11 row_shr:8 row_mask:0xf bank_mask:0x4
    v_mul_f32_dpp v21, v198, v11 row_shr:8 row_mask:0xf bank_mask:0x4
    v_mul_f32_dpp v22, v202, v11 row_shr:8 row_mask:0xf bank_mask:0x4
    v_mul_f32_dpp v23, v206, v11 row_shr:8 row_mask:0xf bank_mask:0x4
    v_mul_f32_dpp v20, v195, v11 row_shr:12 row_mask:0xf bank_mask:0x8
    v_mul_f32_dpp v21, v199, v11 row_shr:12 row_mask:0xf bank_mask:0x8
    v_mul_f32_dpp v22, v203, v11 row_shr:12 row_mask:0xf bank_mask:0x8
    v_mul_f32_dpp v23, v207, v11 row_shr:12 row_mask:0xf bank_mask:0x8
    ds_write_b128 v5, v[20:23] offset:1152
    s_waitcnt vmcnt(0) lgkmcnt(0)
    s_barrier
    s_cmp_ge_u32 s64, 4
    s_cbranch_scc1 L_pub_done
    ds_read_b64 v[32:33], v6 offset:0
    ds_read_b64 v[34:35], v6 offset:2304
    ds_read_b64 v[36:37], v6 offset:4608
    ds_read_b64 v[38:39], v6 offset:6912
    ds_read_b64 v[40:41], v6 offset:9216
    ds_read_b64 v[42:43], v6 offset:11520
    ds_read_b64 v[44:45], v6 offset:13824
    ds_read_b64 v[46:47], v6 offset:16128
    s_waitcnt lgkmcnt(6)
    v_pk_add_f32 v[32:33], v[32:33], v[34:35]
    s_waitcnt lgkmcnt(5)
    v_pk_add_f32 v[32:33], v[32:33], v[36:37]
    s_waitcnt lgkmcnt(4)
    v_pk_add_f32 v[32:33], v[32:33], v[38:39]
    s_waitcnt lgkmcnt(3)
    v_pk_add_f32 v[32:33], v[32:33], v[40:41]
    s_waitcnt lgkmcnt(2)
    v_pk_add_f32 v[32:33], v[32:33], v[42:43]
    s_waitcnt lgkmcnt(1)
    v_pk_add_f32 v[32:33], v[32:33], v[44:45]
    s_waitcnt lgkmcnt(0)
    v_pk_add_f32 v[32:33], v[32:33], v[46:47]
    v_cvt_pk_bf16_f32 v32, v32, v33
    v_min_u32 v32, -2, v32
    s_cmp_eq_u32 s69, 0
    s_cbranch_scc1 L_st_22_slow
    buffer_store_dword v32, v7, s[40:43], s76 offen
L_st_22_done:
L_pub_done:
    s_cmp_eq_u32 s65, 2
    s_cbranch_scc1 L_role_o
    s_cmp_eq_u32 s65, 4
    s_cbranch_scc1 L_role_fd
    s_cmp_eq_u32 s65, 1
    s_cbranch_scc1 L_role_r
    s_branch L_fin
L_role_o:
    s_lshl_b32 s76, s60, 15
    s_lshl_b32 s72, s64, 12
    s_add_u32 s76, s76, s72
    s_add_u32 s76, s76, 262144
    buffer_load_dwordx4 v[32:35], v2, s[40:43], s76 offen offset:0 sc1
    buffer_load_dwordx4 v[36:39], v2, s[40:43], s76 offen offset:1024 sc1
    buffer_load_dwordx4 v[40:43], v2, s[40:43], s76 offen offset:2048 sc1
    buffer_load_dwordx4 v[44:47], v2, s[40:43], s76 offen offset:3072 sc1
    v_lshrrev_b32 v3, 4, v0
    v_bfe_u32 v4, v0, 2, 2
    v_lshl_add_u32 v5, v3, 3, v4
    v_lshlrev_b32 v5, 7, v5
    v_and_b32 v3, 1, v3
    v_lshlrev_b32 v3, 1, v3
    v_lshrrev_b32 v4, 1, v4
    v_or_b32 v3, v3, v4
    v_lshl_add_u32 v5, v3, 5, v5
    v_and_b32 v4, 3, v0
    v_lshl_add_u32 v9, v4, 3, v5
    s_lshl_b32 s72, s64, 13
    v_add_u32 v9, s72, v9
    ds_read_b64_tr_b16 v[64:65], v9 offset:0
    ds_read_b64_tr_b16 v[66:67], v9 offset:512
    ds_read_b64_tr_b16 v[68:69], v9 offset:4096
    ds_read_b64_tr_b16 v[70:71], v9 offset:4608
    v_xor_b32 v10, 32, v9
    ds_read_b64_tr_b16 v[72:73], v10 offset:0
    ds_read_b64_tr_b16 v[74:75], v10 offset:512
    ds_read_b64_tr_b16 v[76:77], v10 offset:4096
    ds_read_b64_tr_b16 v[78:79], v10 offset:4608
    v_xor_b32 v10, 64, v9
    ds_read_b64_tr_b16 v[80:81], v10 offset:0
    ds_read_b64_tr_b16 v[82:83], v10 offset:512
    ds_read_b64_tr_b16 v[84:85], v10 offset:4096
    ds_read_b64_tr_b16 v[86:87], v10 offset:4608
    v_xor_b32 v10, 96, v9
    ds_read_b64_tr_b16 v[88:89], v10 offset:0
    ds_read_b64_tr_b16 v[90:91], v10 offset:512
    ds_read_b64_tr_b16 v[92:93], v10 offset:4096
    ds_read_b64_tr_b16 v[94:95], v10 offset:4608
    v_and_b32 v3, 3, v0
    v_mul_u32_u24 v3, 272, v3
    v_bfe_u32 v4, v0, 2, 2
    v_lshl_add_u32 v3, v4, 6, v3
    v_lshrrev_b32 v4, 4, v0
    v_lshl_add_u32 v3, v4, 4, v3
    s_mul_i32 s72, s64, 1088
    s_add_u32 s72, s72, 65536
    v_add_u32 v5, s72, v3
    s_mul_i32 s72, s64, 272
    s_add_u32 s72, s72, 65536
    v_lshl_add_u32 v6, v0, 2, s72
    s_lshl_b32 s72, s64, 10
    v_lshl_add_u32 v7, v0, 1, s72
    v_mov_b32 v48, 0
    v_mov_b32 v49, 0
    v_mov_b32 v50, 0
    v_mov_b32 v51, 0
    v_mov_b32 v52, 0
    v_mov_b32 v53, 0
    v_mov_b32 v54, 0
    v_mov_b32 v55, 0
    v_mov_b32 v56, 0
    v_mov_b32 v57, 0
    v_mov_b32 v58, 0
    v_mov_b32 v59, 0
    v_mov_b32 v60, 0
    v_mov_b32 v61, 0
    v_mov_b32 v62, 0
    v_mov_b32 v63, 0
    s_waitcnt lgkmcnt(0)
    s_mov_b32 s71, 0
    s_waitcnt vmcnt(2)
    v_max3_u32 v3, v32, v33, v34
    v_max3_u32 v3, v35, v36, v3
    v_max3_u32 v3, v37, v38, v3
    v_max_u32 v3, v39, v3
    v_cmp_eq_u32 vcc, -1, v3
    s_cbranch_vccnz L_po_23_s0
L_po_23_r0:
    v_mfma_f32_16x16x32_bf16 v[48:51], v[64:67], v[32:35], v[48:51]
    v_mfma_f32_16x16x32_bf16 v[52:55], v[72:75], v[32:35], v[52:55]
    v_mfma_f32_16x16x32_bf16 v[56:59], v[80:83], v[32:35], v[56:59]
    v_mfma_f32_16x16x32_bf16 v[60:63], v[88:91], v[32:35], v[60:63]
    v_mfma_f32_16x16x32_bf16 v[48:51], v[68:71], v[36:39], v[48:51]
    v_mfma_f32_16x16x32_bf16 v[52:55], v[76:79], v[36:39], v[52:55]
    v_mfma_f32_16x16x32_bf16 v[56:59], v[84:87], v[36:39], v[56:59]
    v_mfma_f32_16x16x32_bf16 v[60:63], v[92:95], v[36:39], v[60:63]
    s_waitcnt vmcnt(0)
    v_max3_u32 v3, v40, v41, v42
    v_max3_u32 v3, v43, v44, v3
    v_max3_u32 v3, v45, v46, v3
    v_max_u32 v3, v47, v3
    v_cmp_eq_u32 vcc, -1, v3
    s_cbranch_vccnz L_po_23_s1
L_po_23_r1:
    v_mfma_f32_16x16x32_bf16 v[48:51], v[64:67], v[40:43], v[48:51]
    v_mfma_f32_16x16x32_bf16 v[52:55], v[72:75], v[40:43], v[52:55]
    v_mfma_f32_16x16x32_bf16 v[56:59], v[80:83], v[40:43], v[56:59]
    v_mfma_f32_16x16x32_bf16 v[60:63], v[88:91], v[40:43], v[60:63]
    v_mfma_f32_16x16x32_bf16 v[48:51], v[68:71], v[44:47], v[48:51]
    v_mfma_f32_16x16x32_bf16 v[52:55], v[76:79], v[44:47], v[52:55]
    v_mfma_f32_16x16x32_bf16 v[56:59], v[84:87], v[44:47], v[56:59]
    v_mfma_f32_16x16x32_bf16 v[60:63], v[92:95], v[44:47], v[60:63]
    s_nop 4
    v_add_f32_dpp v32, v48, v48 row_ror:8 row_mask:0xf bank_mask:0x3
    v_add_f32_dpp v33, v49, v49 row_ror:8 row_mask:0xf bank_mask:0x3
    v_add_f32_dpp v34, v50, v50 row_ror:8 row_mask:0xf bank_mask:0x3
    v_add_f32_dpp v35, v51, v51 row_ror:8 row_mask:0xf bank_mask:0x3
    v_add_f32_dpp v36, v52, v52 row_ror:8 row_mask:0xf bank_mask:0x3
    v_add_f32_dpp v37, v53, v53 row_ror:8 row_mask:0xf bank_mask:0x3
    v_add_f32_dpp v38, v54, v54 row_ror:8 row_mask:0xf bank_mask:0x3
    v_add_f32_dpp v39, v55, v55 row_ror:8 row_mask:0xf bank_mask:0x3
    v_add_f32_dpp v32, v56, v56 row_ror:8 row_mask:0xf bank_mask:0xc
    v_add_f32_dpp v33, v57, v57 row_ror:8 row_mask:0xf bank_mask:0xc
    v_add_f32_dpp v34, v58, v58 row_ror:8 row_mask:0xf bank_mask:0xc
    v_add_f32_dpp v35, v59, v59 row_ror:8 row_mask:0xf bank_mask:0xc
    v_add_f32_dpp v36, v60, v60 row_ror:8 row_mask:0xf bank_mask:0xc
    v_add_f32_dpp v37, v61, v61 row_ror:8 row_mask:0xf bank_mask:0xc
    v_add_f32_dpp v38, v62, v62 row_ror:8 row_mask:0xf bank_mask:0xc
    v_add_f32_dpp v39, v63, v63 row_ror:8 row_mask:0xf bank_mask:0xc
    v_add_f32_dpp v40, v32, v32 row_shl:4 row_mask:0xf bank_mask:0x5
    v_add_f32_dpp v41, v33, v33 row_shl:4 row_mask:0xf bank_mask:0x5
    v_add_f32_dpp v42, v34, v34 row_shl:4 row_mask:0xf bank_mask:0x5
    v_add_f32_dpp v43, v35, v35 row_shl:4 row_mask:0xf bank_mask:0x5
    v_add_f32_dpp v40, v36, v36 row_shr:4 row_mask:0xf bank_mask:0xa
    v_add_f32_dpp v41, v37, v37 row_shr:4 row_mask:0xf bank_mask:0xa
    v_add_f32_dpp v42, v38, v38 row_shr:4 row_mask:0xf bank_mask:0xa
    v_add_f32_dpp v43, v39, v39 row_shr:4 row_mask:0xf bank_mask:0xa
    ds_write_b128 v5, v[40:43]
    s_waitcnt lgkmcnt(0)
    s_barrier
    s_cmp_ge_u32 s64, 4
    s_cbranch_scc1 L_o_hi
    ds_read_b32 v32, v6 offset:0
    ds_read_b32 v33, v6 offset:1088
    ds_read_b32 v34, v6 offset:2176
    ds_read_b32 v35, v6 offset:3264
    ds_read_b32 v36, v6 offset:4352
    ds_read_b32 v37, v6 offset:5440
    ds_read_b32 v38, v6 offset:6528
    ds_read_b32 v39, v6 offset:7616
    s_waitcnt lgkmcnt(6)
    v_add_f32 v32, v32, v33
    s_waitcnt lgkmcnt(5)
    v_add_f32 v32, v32, v34
    s_waitcnt lgkmcnt(4)
    v_add_f32 v32, v32, v35
    s_waitcnt lgkmcnt(3)
    v_add_f32 v32, v32, v36
    s_waitcnt lgkmcnt(2)
    v_add_f32 v32, v32, v37
    s_waitcnt lgkmcnt(1)
    v_add_f32 v32, v32, v38
    s_waitcnt lgkmcnt(0)
    v_add_f32 v32, v32, v39
    s_mov_b32 s72, 0x55555555
    s_nop 0
    v_mov_b32_dpp v33, v32 quad_perm:[1,0,3,2] row_mask:0xf bank_mask:0xf
    s_mov_b32 exec_lo, s72
    s_mov_b32 exec_hi, s72
    v_cvt_pk_bf16_f32 v32, v32, v33
    v_min_u32 v32, -2, v32
    buffer_store_dword v32, v7, s[40:43], s74 offen sc1
    s_branch L_fin
L_role_fd:
    v_lshrrev_b32 v3, 4, v0
    v_bfe_u32 v4, v0, 2, 2
    v_lshl_add_u32 v5, v3, 3, v4
    v_lshlrev_b32 v5, 10, v5
    v_and_b32 v3, 1, v4
    v_lshlrev_b32 v3, 3, v3
    v_lshrrev_b32 v4, 1, v4
    v_or_b32 v3, v3, v4
    v_and_b32 v4, 3, v0
    v_lshlrev_b32 v4, 1, v4
    s_lshl_b32 s72, s64, 3
    v_add_u32 v4, s72, v4
    v_xor_b32 v6, v4, v3
    v_lshl_add_u32 v6, v6, 4, v5
    v_add_u32 v6, 65536, v6
    v_xor_b32 v7, 16, v6
    ds_read_b64_tr_b16 v[96:97], v6 offset:0
    ds_read_b64_tr_b16 v[98:99], v6 offset:4096
    ds_read_b64_tr_b16 v[100:101], v6 offset:8
    ds_read_b64_tr_b16 v[102:103], v6 offset:4104
    ds_read_b64_tr_b16 v[104:105], v7 offset:0
    ds_read_b64_tr_b16 v[106:107], v7 offset:4096
    ds_read_b64_tr_b16 v[108:109], v7 offset:8
    ds_read_b64_tr_b16 v[110:111], v7 offset:4104
    v_bfe_u32 v3, v0, 2, 2
    v_lshrrev_b32 v4, 4, v0
    v_lshlrev_b32 v5, 6, v3
    v_lshl_add_u32 v5, v4, 4, v5
    v_add_u32 v12, 121408, v5
    v_lshlrev_b32 v5, 11, v3
    v_lshl_add_u32 v5, v4, 6, v5
    v_and_b32 v3, 3, v0
    v_lshl_add_u32 v5, v3, 4, v5
    s_lshl_b32 s72, s64, 8
    v_add_u32 v13, s72, v5
    s_mov_b32 s88, 0x22222222
    s_mov_b32 s89, 0x22222222
    s_mov_b32 s90, 0x44444444
    s_mov_b32 s91, 0x44444444
    s_mov_b32 s92, 0x88888888
    s_mov_b32 s93, 0x88888888
    s_cmp_ge_u32 s64, 4
    s_cbranch_scc1 L_fd_bar1
    s_lshl_b32 s76, s64, 10
    s_add_u32 s76, s76, 98304
    s_add_u32 s6, s76, 0
    s_add_u32 s7, s76, 4096
    s_add_u32 s8, s76, 8192
    s_add_u32 s9, s76, 12288
    s_add_u32 s10, s76, 16384
    s_add_u32 s11, s76, 20480
    s_add_u32 s12, s76, 24576
    s_add_u32 s13, s76, 28672
    buffer_load_dwordx4 v[176:179], v2, s[40:43], s6 offen sc1
    buffer_load_dwordx4 v[180:183], v2, s[40:43], s7 offen sc1
    buffer_load_dwordx4 v[184:187], v2, s[40:43], s8 offen sc1
    buffer_load_dwordx4 v[188:191], v2, s[40:43], s9 offen sc1
    buffer_load_dwordx4 v[192:195], v2, s[40:43], s10 offen sc1
    buffer_load_dwordx4 v[196:199], v2, s[40:43], s11 offen sc1
    buffer_load_dwordx4 v[200:203], v2, s[40:43], s12 offen sc1
    buffer_load_dwordx4 v[204:207], v2, s[40:43], s13 offen sc1
    v_lshrrev_b32 v3, 4, v0
    v_bfe_u32 v4, v0, 2, 2
    v_lshl_add_u32 v5, v3, 3, v4
    v_lshlrev_b32 v5, 6, v5
    v_bfe_u32 v4, v0, 1, 1
    v_lshl_add_u32 v5, v4, 15, v5
    v_and_b32 v3, 1, v3
    v_lshl_or_b32 v3, v4, 1, v3
    v_xor_b32 v3, s64, v3
    v_lshl_add_u32 v5, v3, 4, v5
    v_and_b32 v3, 1, v0
    v_lshl_add_u32 v6, v3, 3, v5
    ds_read_b64_tr_b16 v[112:113], v6 offset:0
    ds_read_b64_tr_b16 v[114:115], v6 offset:256
    ds_read_b64_tr_b16 v[116:117], v6 offset:2048
    ds_read_b64_tr_b16 v[118:119], v6 offset:2304
    ds_read_b64_tr_b16 v[120:121], v6 offset:4096
    ds_read_b64_tr_b16 v[122:123], v6 offset:4352
    ds_read_b64_tr_b16 v[124:125], v6 offset:6144
    ds_read_b64_tr_b16 v[126:127], v6 offset:6400
    ds_read_b64_tr_b16 v[128:129], v6 offset:8192
    ds_read_b64_tr_b16 v[130:131], v6 offset:8448
    ds_read_b64_tr_b16 v[132:133], v6 offset:10240
    ds_read_b64_tr_b16 v[134:135], v6 offset:10496
    ds_read_b64_tr_b16 v[136:137], v6 offset:12288
    ds_read_b64_tr_b16 v[138:139], v6 offset:12544
    ds_read_b64_tr_b16 v[140:141], v6 offset:14336
    ds_read_b64_tr_b16 v[142:143], v6 offset:14592
    ds_read_b64_tr_b16 v[144:145], v6 offset:16384
    ds_read_b64_tr_b16 v[146:147], v6 offset:16640
    ds_read_b64_tr_b16 v[148:149], v6 offset:18432
    ds_read_b64_tr_b16 v[150:151], v6 offset:18688
    ds_read_b64_tr_b16 v[152:153], v6 offset:20480
    ds_read_b64_tr_b16 v[154:155], v6 offset:20736
    ds_read_b64_tr_b16 v[156:157], v6 offset:22528
    ds_read_b64_tr_b16 v[158:159], v6 offset:22784
    ds_read_b64_tr_b16 v[160:161], v6 offset:24576
    ds_read_b64_tr_b16 v[162:163], v6 offset:24832
    ds_read_b64_tr_b16 v[164:165], v6 offset:26624
    ds_read_b64_tr_b16 v[166:167], v6 offset:26880
    ds_read_b64_tr_b16 v[168:169], v6 offset:28672
    ds_read_b64_tr_b16 v[170:171], v6 offset:28928
    ds_read_b64_tr_b16 v[172:173], v6 offset:30720
    ds_read_b64_tr_b16 v[174:175], v6 offset:30976
    v_and_b32 v3, 3, v0
    v_mul_u32_u24 v4, 1088, v3
    v_lshrrev_b32 v5, 4, v0
    v_lshl_add_u32 v14, v5, 4, v4
    v_add_u32 v14, 98304, v14
    s_mul_i32 s72, s64, 1088
    s_add_u32 s72, s72, 98304
    v_add_u32 v15, s72, v2
    v_lshlrev_b32 v3, 6, v3
    v_and_b32 v5, 1, v5
    v_lshl_add_u32 v3, v5, 3, v3
    v_bfe_u32 v4, v0, 2, 2
    v_lshl_add_u32 v3, v4, 1, v3
    s_lshl_b32 s72, s64, 4
    s_add_u32 s72, s72, 121408
    v_add_u32 v9, s72, v3
    s_mul_i32 s73, s64, 6144
    s_add_u32 s73, s73, 2048
    v_max3_u32 v3, v28, v29, v30
    v_max3_u32 v3, v31, v244, v3
    v_max3_u32 v3, v245, v246, v3
    v_max3_u32 v3, v247, v248, v3
    v_max3_u32 v3, v249, v250, v3
    v_max_u32 v3, v251, v3
    v_cmp_eq_u32 vcc, -1, v3
    s_cbranch_vccnz L_pmod_24_spin
L_pmod_24_ok:
    v_lshlrev_b32 v48, 16, v24
    v_and_b32 v49, 0xffff0000, v24
    v_lshlrev_b32 v50, 16, v25
    v_and_b32 v51, 0xffff0000, v25
    v_lshlrev_b32 v52, 16, v26
    v_and_b32 v53, 0xffff0000, v26
    v_lshlrev_b32 v54, 16, v27
    v_and_b32 v55, 0xffff0000, v27
    v_lshlrev_b32 v56, 16, v28
    v_and_b32 v57, 0xffff0000, v28
    v_lshlrev_b32 v58, 16, v29
    v_and_b32 v59, 0xffff0000, v29
    v_lshlrev_b32 v60, 16, v30
    v_and_b32 v61, 0xffff0000, v30
    v_lshlrev_b32 v62, 16, v31
    v_and_b32 v63, 0xffff0000, v31
    v_lshlrev_b32 v64, 16, v244
    v_and_b32 v65, 0xffff0000, v244
    v_lshlrev_b32 v66, 16, v245
    v_and_b32 v67, 0xffff0000, v245
    v_lshlrev_b32 v68, 16, v246
    v_and_b32 v69, 0xffff0000, v246
    v_lshlrev_b32 v70, 16, v247
    v_and_b32 v71, 0xffff0000, v247
    v_lshlrev_b32 v72, 16, v248
    v_and_b32 v73, 0xffff0000, v248
    v_lshlrev_b32 v74, 16, v249
    v_and_b32 v75, 0xffff0000, v249
    v_lshlrev_b32 v76, 16, v250
    v_and_b32 v77, 0xffff0000, v250
    v_lshlrev_b32 v78, 16, v251
    v_and_b32 v79, 0xffff0000, v251
    v_add_f32 v72, 1.0, v72
    v_add_f32 v73, 1.0, v73
    v_add_f32 v74, 1.0, v74
    v_add_f32 v75, 1.0, v75
    v_add_f32 v76, 1.0, v76
    v_add_f32 v77, 1.0, v77
    v_add_f32 v78, 1.0, v78
    v_add_f32 v79, 1.0, v79
    v_mov_b32 v80, 0
    v_mov_b32 v81, 0
    v_mov_b32 v82, 0
    v_mov_b32 v83, 0
    v_mov_b32 v84, 0
    v_mov_b32 v85, 0
    v_mov_b32 v86, 0
    v_mov_b32 v87, 0
    s_waitcnt lgkmcnt(0)
    s_mov_b32 s71, 0
    s_waitcnt vmcnt(7)
    v_max3_u32 v3, v176, v177, v178
    v_max_u32 v3, v179, v3
    v_cmp_eq_u32 vcc, -1, v3
    s_cbranch_vccnz L_px_25_s0
L_px_25_r0:
    v_dot2c_f32_bf16 v80, s96, v176
    v_dot2c_f32_bf16 v81, s97, v176
    v_dot2c_f32_bf16 v82, s96, v177
    v_dot2c_f32_bf16 v83, s97, v177
    v_dot2c_f32_bf16 v84, s96, v178
    v_dot2c_f32_bf16 v85, s97, v178
    v_dot2c_f32_bf16 v86, s96, v179
    v_dot2c_f32_bf16 v87, s97, v179
    s_waitcnt vmcnt(6)
    v_max3_u32 v3, v180, v181, v182
    v_max_u32 v3, v183, v3
    v_cmp_eq_u32 vcc, -1, v3
    s_cbranch_vccnz L_px_25_s1
L_px_25_r1:
    v_dot2c_f32_bf16 v80, s96, v180
    v_dot2c_f32_bf16 v81, s97, v180
    v_dot2c_f32_bf16 v82, s96, v181
    v_dot2c_f32_bf16 v83, s97, v181
    v_dot2c_f32_bf16 v84, s96, v182
    v_dot2c_f32_bf16 v85, s97, v182
    v_dot2c_f32_bf16 v86, s96, v183
    v_dot2c_f32_bf16 v87, s97, v183
    s_waitcnt vmcnt(5)
    v_max3_u32 v3, v184, v185, v186
    v_max_u32 v3, v187, v3
    v_cmp_eq_u32 vcc, -1, v3
    s_cbranch_vccnz L_px_25_s2
L_px_25_r2:
    v_dot2c_f32_bf16 v80, s96, v184
    v_dot2c_f32_bf16 v81, s97, v184
    v_dot2c_f32_bf16 v82, s96, v185
    v_dot2c_f32_bf16 v83, s97, v185
    v_dot2c_f32_bf16 v84, s96, v186
    v_dot2c_f32_bf16 v85, s97, v186
    v_dot2c_f32_bf16 v86, s96, v187
    v_dot2c_f32_bf16 v87, s97, v187
    s_waitcnt vmcnt(4)
    v_max3_u32 v3, v188, v189, v190
    v_max_u32 v3, v191, v3
    v_cmp_eq_u32 vcc, -1, v3
    s_cbranch_vccnz L_px_25_s3
L_px_25_r3:
    v_dot2c_f32_bf16 v80, s96, v188
    v_dot2c_f32_bf16 v81, s97, v188
    v_dot2c_f32_bf16 v82, s96, v189
    v_dot2c_f32_bf16 v83, s97, v189
    v_dot2c_f32_bf16 v84, s96, v190
    v_dot2c_f32_bf16 v85, s97, v190
    v_dot2c_f32_bf16 v86, s96, v191
    v_dot2c_f32_bf16 v87, s97, v191
    s_waitcnt vmcnt(3)
    v_max3_u32 v3, v192, v193, v194
    v_max_u32 v3, v195, v3
    v_cmp_eq_u32 vcc, -1, v3
    s_cbranch_vccnz L_px_25_s4
L_px_25_r4:
    v_dot2c_f32_bf16 v80, s96, v192
    v_dot2c_f32_bf16 v81, s97, v192
    v_dot2c_f32_bf16 v82, s96, v193
    v_dot2c_f32_bf16 v83, s97, v193
    v_dot2c_f32_bf16 v84, s96, v194
    v_dot2c_f32_bf16 v85, s97, v194
    v_dot2c_f32_bf16 v86, s96, v195
    v_dot2c_f32_bf16 v87, s97, v195
    s_waitcnt vmcnt(2)
    v_max3_u32 v3, v196, v197, v198
    v_max_u32 v3, v199, v3
    v_cmp_eq_u32 vcc, -1, v3
    s_cbranch_vccnz L_px_25_s5
L_px_25_r5:
    v_dot2c_f32_bf16 v80, s96, v196
    v_dot2c_f32_bf16 v81, s97, v196
    v_dot2c_f32_bf16 v82, s96, v197
    v_dot2c_f32_bf16 v83, s97, v197
    v_dot2c_f32_bf16 v84, s96, v198
    v_dot2c_f32_bf16 v85, s97, v198
    v_dot2c_f32_bf16 v86, s96, v199
    v_dot2c_f32_bf16 v87, s97, v199
    s_waitcnt vmcnt(1)
    v_max3_u32 v3, v200, v201, v202
    v_max_u32 v3, v203, v3
    v_cmp_eq_u32 vcc, -1, v3
    s_cbranch_vccnz L_px_25_s6
L_px_25_r6:
    v_dot2c_f32_bf16 v80, s96, v200
    v_dot2c_f32_bf16 v81, s97, v200
    v_dot2c_f32_bf16 v82, s96, v201
    v_dot2c_f32_bf16 v83, s97, v201
    v_dot2c_f32_bf16 v84, s96, v202
    v_dot2c_f32_bf16 v85, s97, v202
    v_dot2c_f32_bf16 v86, s96, v203
    v_dot2c_f32_bf16 v87, s97, v203
    s_waitcnt vmcnt(0)
    v_max3_u32 v3, v204, v205, v206
    v_max_u32 v3, v207, v3
    v_cmp_eq_u32 vcc, -1, v3
    s_cbranch_vccnz L_px_25_s7
L_px_25_r7:
    v_dot2c_f32_bf16 v80, s96, v204
    v_dot2c_f32_bf16 v81, s97, v204
    v_dot2c_f32_bf16 v82, s96, v205
    v_dot2c_f32_bf16 v83, s97, v205
    v_dot2c_f32_bf16 v84, s96, v206
    v_dot2c_f32_bf16 v85, s97, v206
    v_dot2c_f32_bf16 v86, s96, v207
    v_dot2c_f32_bf16 v87, s97, v207
    v_pk_fma_f32 v[48:49], v[56:57], v[80:81], v[48:49]
    v_pk_fma_f32 v[50:51], v[58:59], v[82:83], v[50:51]
    v_pk_fma_f32 v[52:53], v[60:61], v[84:85], v[52:53]
    v_pk_fma_f32 v[54:55], v[62:63], v[86:87], v[54:55]
    v_readfirstlane_b32 s72, v48
    s_nop 1
    v_pk_add_f32 v[48:49], v[48:49], s[72:73] op_sel_hi:[1,0] neg_lo:[0,1] neg_hi:[0,1]
    v_pk_add_f32 v[50:51], v[50:51], s[72:73] op_sel_hi:[1,0] neg_lo:[0,1] neg_hi:[0,1]
    v_pk_add_f32 v[52:53], v[52:53], s[72:73] op_sel_hi:[1,0] neg_lo:[0,1] neg_hi:[0,1]
    v_pk_add_f32 v[54:55], v[54:55], s[72:73] op_sel_hi:[1,0] neg_lo:[0,1] neg_hi:[0,1]
    v_pk_add_f32 v[80:81], v[48:49], v[50:51]
    v_pk_mul_f32 v[82:83], v[48:49], v[48:49]
    v_pk_add_f32 v[80:81], v[80:81], v[52:53]
    v_pk_fma_f32 v[82:83], v[50:51], v[50:51], v[82:83]
    v_pk_add_f32 v[80:81], v[80:81], v[54:55]
    v_pk_fma_f32 v[82:83], v[52:53], v[52:53], v[82:83]
    v_add_f32 v80, v80, v81
    v_pk_fma_f32 v[82:83], v[54:55], v[54:55], v[82:83]
    v_add_f32 v81, v82, v83
    s_nop 1
    v_add_f32_dpp v81, v81, v81 quad_perm:[1,0,3,2] row_mask:0xf bank_mask:0xf
    v_add_f32_dpp v80, v80, v80 quad_perm:[1,0,3,2] row_mask:0xf bank_mask:0xf
    s_nop 0
    v_add_f32_dpp v81, v81, v81 quad_perm:[2,3,0,1] row_mask:0xf bank_mask:0xf
    v_add_f32_dpp v80, v80, v80 quad_perm:[2,3,0,1] row_mask:0xf bank_mask:0xf
    s_nop 0
    v_add_f32_dpp v81, v81, v81 row_ror:4 row_mask:0xf bank_mask:0xf
    v_add_f32_dpp v80, v80, v80 row_ror:4 row_mask:0xf bank_mask:0xf
    s_nop 0
    v_add_f32_dpp v81, v81, v81 row_ror:8 row_mask:0xf bank_mask:0xf
    v_add_f32_dpp v80, v80, v80 row_ror:8 row_mask:0xf bank_mask:0xf
    v_mov_b32 v83, v81
    v_mov_b32 v82, v80
    s_nop 0
    v_permlane16_swap_b32 v81, v83
    v_permlane16_swap_b32 v80, v82
    v_add_f32 v81, v81, v83
    v_add_f32 v80, v80, v82
    v_mov_b32 v83, v81
    v_mov_b32 v82, v80
    s_nop 0
    v_permlane32_swap_b32 v81, v83
    v_permlane32_swap_b32 v80, v82
    v_add_f32 v81, v81, v83
    v_add_f32 v80, v80, v82
    v_mul_f32 v80, 0x3b000000, v80
    v_mov_b32 v82, 0x3727c5ac
    v_fmac_f32 v82, 0x3b000000, v81
    v_fma_f32 v82, -v80, v80, v82
    v_max_f32 v82, 0x3727c5ac, v82
    v_rsq_f32 v81, v82
    s_nop 0
    v_pk_add_f32 v[48:49], v[48:49], v[80:81] op_sel_hi:[1,0] neg_lo:[0,1] neg_hi:[0,1]
    v_pk_add_f32 v[50:51], v[50:51], v[80:81] op_sel_hi:[1,0] neg_lo:[0,1] neg_hi:[0,1]
    v_pk_add_f32 v[52:53], v[52:53], v[80:81] op_sel_hi:[1,0] neg_lo:[0,1] neg_hi:[0,1]
    v_pk_add_f32 v[54:55], v[54:55], v[80:81] op_sel_hi:[1,0] neg_lo:[0,1] neg_hi:[0,1]
    v_pk_mul_f32 v[72:73], v[72:73], v[80:81] op_sel:[0,1] op_sel_hi:[1,1]
    v_pk_mul_f32 v[74:75], v[74:75], v[80:81] op_sel:[0,1] op_sel_hi:[1,1]
    v_pk_mul_f32 v[76:77], v[76:77], v[80:81] op_sel:[0,1] op_sel_hi:[1,1]
    v_pk_mul_f32 v[78:79], v[78:79], v[80:81] op_sel:[0,1] op_sel_hi:[1,1]
    v_pk_fma_f32 v[48:49], v[48:49], v[72:73], v[64:65]
    v_pk_fma_f32 v[50:51], v[50:51], v[74:75], v[66:67]
    v_pk_fma_f32 v[52:53], v[52:53], v[76:77], v[68:69]
    v_pk_fma_f32 v[54:55], v[54:55], v[78:79], v[70:71]
    v_cvt_pk_bf16_f32 v32, v48, v49
    v_cvt_pk_bf16_f32 v33, v50, v51
    v_cvt_pk_bf16_f32 v34, v52, v53
    v_cvt_pk_bf16_f32 v35, v54, v55
    ds_write_b128 v15, v[32:35]
L_fd_bar1:
    s_waitcnt lgkmcnt(0)
    s_barrier
    s_cmp_ge_u32 s64, 4
    s_cbranch_scc1 L_fd_bar2
    ds_read_b128 v[176:179], v14 offset:0
    ds_read_b128 v[180:183], v14 offset:64
    ds_read_b128 v[184:187], v14 offset:128
    ds_read_b128 v[188:191], v14 offset:192
    ds_read_b128 v[192:195], v14 offset:256
    ds_read_b128 v[196:199], v14 offset:320
    ds_read_b128 v[200:203], v14 offset:384
    ds_read_b128 v[204:207], v14 offset:448
    ds_read_b128 v[208:211], v14 offset:512
    ds_read_b128 v[212:215], v14 offset:576
    ds_read_b128 v[216:219], v14 offset:640
    ds_read_b128 v[220:223], v14 offset:704
    ds_read_b128 v[224:227], v14 offset:768
    ds_read_b128 v[228:231], v14 offset:832
    ds_read_b128 v[232:235], v14 offset:896
    ds_read_b128 v[236:239], v14 offset:960
    s_waitcnt lgkmcnt(15)
    v_mfma_f32_16x16x32_bf16 v[32:35], v[112:115], v[176:179], 0
    s_waitcnt lgkmcnt(14)
    v_mfma_f32_16x16x32_bf16 v[32:35], v[116:119], v[180:183], v[32:35]
    s_waitcnt lgkmcnt(13)
    v_mfma_f32_16x16x32_bf16 v[32:35], v[120:123], v[184:187], v[32:35]
    s_waitcnt lgkmcnt(12)
    v_mfma_f32_16x16x32_bf16 v[32:35], v[124:127], v[188:191], v[32:35]
    s_waitcnt lgkmcnt(11)
    v_mfma_f32_16x16x32_bf16 v[32:35], v[128:131], v[192:195], v[32:35]
    s_waitcnt lgkmcnt(10)
    v_mfma_f32_16x16x32_bf16 v[32:35], v[132:135], v[196:199], v[32:35]
    s_waitcnt lgkmcnt(9)
    v_mfma_f32_16x16x32_bf16 v[32:35], v[136:139], v[200:203], v[32:35]
    s_waitcnt lgkmcnt(8)
    v_mfma_f32_16x16x32_bf16 v[32:35], v[140:143], v[204:207], v[32:35]
    s_waitcnt lgkmcnt(7)
    v_mfma_f32_16x16x32_bf16 v[32:35], v[144:147], v[208:211], v[32:35]
    s_waitcnt lgkmcnt(6)
    v_mfma_f32_16x16x32_bf16 v[32:35], v[148:151], v[212:215], v[32:35]
    s_waitcnt lgkmcnt(5)
    v_mfma_f32_16x16x32_bf16 v[32:35], v[152:155], v[216:219], v[32:35]
    s_waitcnt lgkmcnt(4)
    v_mfma_f32_16x16x32_bf16 v[32:35], v[156:159], v[220:223], v[32:35]
    s_waitcnt lgkmcnt(3)
    v_mfma_f32_16x16x32_bf16 v[32:35], v[160:163], v[224:227], v[32:35]
    s_waitcnt lgkmcnt(2)
    v_mfma_f32_16x16x32_bf16 v[32:35], v[164:167], v[228:231], v[32:35]
    s_waitcnt lgkmcnt(1)
    v_mfma_f32_16x16x32_bf16 v[32:35], v[168:171], v[232:235], v[32:35]
    s_waitcnt lgkmcnt(0)
    v_mfma_f32_16x16x32_bf16 v[32:35], v[172:175], v[236:239], v[32:35]
    v_mov_b32 v39, 0xc0135761
    s_nop 6
    v_mov_b32 v36, v32
    s_nop 1
    v_mov_b32_dpp v36, v33 quad_perm:[0,1,2,3] row_mask:0xf bank_mask:0x2
    s_nop 1
    v_mov_b32_dpp v36, v34 quad_perm:[0,1,2,3] row_mask:0xf bank_mask:0x4
    s_nop 1
    v_mov_b32_dpp v36, v35 quad_perm:[0,1,2,3] row_mask:0xf bank_mask:0x8
    v_mov_b32 v37, v36
    s_nop 1
    v_permlane32_swap_b32 v36, v37
    v_mul_f32 v38, v36, v36
    v_fmac_f32 v39, 0xbdd2d3e8, v38
    v_mul_f32 v39, v39, v36
    v_exp_f32 v39, v39
    v_mul_f32 v37, v37, v36
    v_add_f32 v39, 1.0, v39
    v_rcp_f32 v39, v39
    s_nop 0
    v_mul_f32 v37, v37, v39
    v_cvt_pk_bf16_f32 v37, v37, v37
    ds_write_b16 v9, v37
L_fd_bar2:
    s_waitcnt lgkmcnt(0)
    s_barrier
    ds_read_b128 v[32:35], v12
    s_waitcnt lgkmcnt(0)
    v_mfma_f32_16x16x32_bf16 v[48:51], v[96:99], v[32:35], 0
    v_mfma_f32_16x16x32_bf16 v[52:55], v[100:103], v[32:35], 0
    v_mfma_f32_16x16x32_bf16 v[56:59], v[104:107], v[32:35], 0
    v_mfma_f32_16x16x32_bf16 v[60:63], v[108:111], v[32:35], 0
    s_nop 5
    v_cndmask_b32 v48, v48, v52, s[88:89]
    v_cndmask_b32 v49, v49, v53, s[88:89]
    v_cndmask_b32 v50, v50, v54, s[88:89]
    v_cndmask_b32 v51, v51, v55, s[88:89]
    v_cndmask_b32 v48, v48, v56, s[90:91]
    v_cndmask_b32 v49, v49, v57, s[90:91]
    v_cndmask_b32 v50, v50, v58, s[90:91]
    v_cndmask_b32 v51, v51, v59, s[90:91]
    v_cndmask_b32 v48, v48, v60, s[92:93]
    v_cndmask_b32 v49, v49, v61, s[92:93]
    v_cndmask_b32 v50, v50, v62, s[92:93]
    v_cndmask_b32 v51, v51, v63, s[92:93]
    v_cvt_pk_bf16_f32 v48, v48, v49
    v_cvt_pk_bf16_f32 v50, v50, v51
    v_mov_b32 v49, s95
    v_mov_b32 v51, s95
    buffer_store_dwordx4 v[48:51], v13, s[40:43], s74 offen sc1
    s_branch L_fin
L_role_r:
    s_cmp_eq_u32 s64, 3
    s_cbranch_scc0 L_fin
    s_and_b32 s79, s66, 3
    s_lshr_b32 s76, s66, 2
    s_lshl_b32 s72, s60, 1
    s_add_u32 s76, s76, s72
    s_lshl_b32 s76, s76, 5
    v_and_b32 v3, 7, v0
    v_lshlrev_b32 v3, 2, v3
    v_lshrrev_b32 v4, 5, v0
    v_lshl_add_u32 v3, v4, 1, v3
    v_add_u32 v3, s76, v3
    v_lshlrev_b32 v5, 1, v3
    s_mul_i32 s73, s79, 6144
    s_add_u32 s73, s73, 2048
    v_max_u32 v3, v25, v26
    v_cmp_eq_u32 vcc, -1, v3
    s_cbranch_vccnz L_pr0_26_spin
L_pr0_26_ok:
    v_bfe_u32 v4, v0, 4, 1
    v_lshl_add_u32 v9, v4, 1, v5
    v_lshlrev_b32 v10, 4, v4
    v_bfe_u32 v4, v0, 3, 1
    v_lshl_add_u32 v6, v4, 12, v5
    v_lshrrev_b32 v4, 3, v0
    v_lshlrev_b32 v7, 13, v4
    v_and_b32 v4, 7, v0
    v_lshl_add_u32 v7, v4, 4, v7
    s_lshl_b32 s78, s79, 10
    s_add_u32 s77, s78, 98304
    s_lshl_b32 s72, s79, 11
    s_lshl_b32 s73, s76, 2
    s_add_u32 s72, s72, s73
    s_add_u32 s23, s72, 524288
    s_add_u32 s72, s77, 0
    buffer_load_dword v32, v6, s[40:43], s72 offen sc1
    s_add_u32 s72, s77, 8192
    buffer_load_dword v33, v6, s[40:43], s72 offen sc1
    s_add_u32 s72, s77, 16384
    buffer_load_dword v34, v6, s[40:43], s72 offen sc1
    s_add_u32 s72, s77, 24576
    buffer_load_dword v35, v6, s[40:43], s72 offen sc1
    s_mov_b32 s56, s26
    s_mov_b32 s57, s27
    s_mov_b32 s58, 4096
    s_mov_b32 s59, 0x00020000
    v_lshrrev_b32 v24, v10, v24
    v_lshlrev_b32 v24, 16, v24
    v_lshrrev_b32 v25, v10, v25
    v_lshlrev_b32 v25, 16, v25
    v_lshrrev_b32 v26, v10, v26
    v_lshlrev_b32 v26, 16, v26
    s_waitcnt vmcnt(0)
    v_max3_u32 v3, v32, v33, v34
    v_max_u32 v3, v35, v3
    v_cmp_eq_u32 vcc, -1, v3
    s_cbranch_vccnz L_pr1_27_spin
L_pr1_27_ok:
    s_or_b32 s72, s76, s79
    s_cmp_eq_u32 s72, 0
    s_cbranch_scc0 L_r_gen
    v_mov_b32 v3, s95
    v_mov_b32 v4, 229376
    s_mov_b64 exec, 1
    buffer_store_dword v3, v4, s[40:43], 0 offen sc1
    s_mov_b64 exec, -1
L_r_gen:
    s_add_u32 s22, s23, 0
    buffer_load_dwordx4 v[40:43], v7, s[40:43], s22 offen sc1
    s_add_u32 s22, s23, 65536
    buffer_load_dwordx4 v[44:47], v7, s[40:43], s22 offen sc1
    s_add_u32 s22, s23, 131072
    buffer_load_dwordx4 v[48:51], v7, s[40:43], s22 offen sc1
    s_add_u32 s22, s23, 196608
    buffer_load_dwordx4 v[52:55], v7, s[40:43], s22 offen sc1
    s_add_u32 s22, s23, 262144
    buffer_load_dwordx4 v[56:59], v7, s[40:43], s22 offen sc1
    s_add_u32 s22, s23, 327680
    buffer_load_dwordx4 v[60:63], v7, s[40:43], s22 offen sc1
    s_add_u32 s22, s23, 393216
    buffer_load_dwordx4 v[64:67], v7, s[40:43], s22 offen sc1
    v_lshrrev_b32 v32, v10, v32
    v_lshlrev_b32 v32, 16, v32
    v_lshrrev_b32 v33, v10, v33
    v_lshlrev_b32 v33, 16, v33
    v_lshrrev_b32 v34, v10, v34
    v_lshlrev_b32 v34, 16, v34
    v_lshrrev_b32 v35, v10, v35
    v_lshlrev_b32 v35, 16, v35
    v_add_f32 v32, v32, v33
    v_add_f32 v34, v34, v35
    v_add_f32 v32, v32, v34
    s_nop 1
    v_add_f32_dpp v32, v32, v32 row_ror:8 row_mask:0xf bank_mask:0xf
    v_fmac_f32 v24, v25, v32
    v_mov_b32 v36, 0
    v_mov_b32 v37, 0
    v_mov_b32 v38, 0
    v_mov_b32 v39, 0
    s_mov_b32 s71, 0
    s_waitcnt vmcnt(0)
    v_xor_b32 v3, s95, v41
    v_bitop3_b32 v3, v3, v43, s95 bitop3:0xf6
    v_bitop3_b32 v3, v3, v45, s95 bitop3:0xf6
    v_bitop3_b32 v3, v3, v47, s95 bitop3:0xf6
    v_bitop3_b32 v3, v3, v49, s95 bitop3:0xf6
    v_bitop3_b32 v3, v3, v51, s95 bitop3:0xf6
    v_bitop3_b32 v3, v3, v53, s95 bitop3:0xf6
    v_bitop3_b32 v3, v3, v55, s95 bitop3:0xf6
    v_bitop3_b32 v3, v3, v57, s95 bitop3:0xf6
    v_bitop3_b32 v3, v3, v59, s95 bitop3:0xf6
    v_bitop3_b32 v3, v3, v61, s95 bitop3:0xf6
    v_bitop3_b32 v3, v3, v63, s95 bitop3:0xf6
    v_bitop3_b32 v3, v3, v65, s95 bitop3:0xf6
    v_bitop3_b32 v3, v3, v67, s95 bitop3:0xf6
    v_cmp_ne_u32 vcc, 0, v3
    s_cbranch_vccnz L_pr2_28_s0
L_pr2_28_r0:
    v_dot2c_f32_bf16 v36, s96, v40
    v_dot2c_f32_bf16 v37, s97, v40
    v_dot2c_f32_bf16 v38, s96, v42
    v_dot2c_f32_bf16 v39, s97, v42
    v_dot2c_f32_bf16 v36, s96, v44
    v_dot2c_f32_bf16 v37, s97, v44
    v_dot2c_f32_bf16 v38, s96, v46
    v_dot2c_f32_bf16 v39, s97, v46
    v_dot2c_f32_bf16 v36, s96, v48
    v_dot2c_f32_bf16 v37, s97, v48
    v_dot2c_f32_bf16 v38, s96, v50
    v_dot2c_f32_bf16 v39, s97, v50
    v_dot2c_f32_bf16 v36, s96, v52
    v_dot2c_f32_bf16 v37, s97, v52
    v_dot2c_f32_bf16 v38, s96, v54
    v_dot2c_f32_bf16 v39, s97, v54
    v_dot2c_f32_bf16 v36, s96, v56
    v_dot2c_f32_bf16 v37, s97, v56
    v_dot2c_f32_bf16 v38, s96, v58
    v_dot2c_f32_bf16 v39, s97, v58
    v_dot2c_f32_bf16 v36, s96, v60
    v_dot2c_f32_bf16 v37, s97, v60
    v_dot2c_f32_bf16 v38, s96, v62
    v_dot2c_f32_bf16 v39, s97, v62
    v_dot2c_f32_bf16 v36, s96, v64
    v_dot2c_f32_bf16 v37, s97, v64
    v_dot2c_f32_bf16 v38, s96, v66
    v_dot2c_f32_bf16 v39, s97, v66
    s_nop 1
    v_permlane32_swap_b32 v36, v38
    v_permlane32_swap_b32 v37, v39
    v_add_f32 v36, v36, v38
    v_add_f32 v37, v37, v39
    s_nop 1
    v_permlane16_swap_b32 v36, v37
    v_add_f32 v36, v36, v37
    s_nop 1
    v_add_f32_dpp v36, v36, v36 row_ror:8 row_mask:0xf bank_mask:0xf
    v_fmac_f32 v24, v26, v36
    v_cvt_pk_bf16_f32 v24, v24, v24
    s_mov_b32 exec_lo, 0x00ff00ff
    s_mov_b32 exec_hi, 0x00ff00ff
    buffer_store_short v24, v9, s[56:59], s78 offen
    s_branch L_fin
L_agw_8_spin:
    s_mov_b32 s71, 0
L_agw_8_loop:
    s_sleep 4
    buffer_load_dword v243, v241, s[40:43], s91 offen sc1
    s_waitcnt vmcnt(0)
    v_xor_b32 v3, s95, v243
    v_cmp_le_u32 vcc, 8, v3
    s_cbranch_vccz L_agw_8_ok
    s_add_u32 s71, s71, 1
    s_cmp_lt_u32 s71, 200000
    s_cbranch_scc1 L_agw_8_loop
    s_branch L_agw_8_ok
L_qsub:
    v_xor_b32 v3, s95, v57
    v_xor_b32 v4, s95, v59
    v_or_b32 v3, v3, v4
    v_xor_b32 v4, s95, v61
    v_or_b32 v3, v3, v4
    v_xor_b32 v4, s95, v63
    v_or_b32 v3, v3, v4
    v_xor_b32 v4, s95, v65
    v_or_b32 v3, v3, v4
    v_xor_b32 v4, s95, v67
    v_or_b32 v3, v3, v4
    v_xor_b32 v4, s95, v69
    v_or_b32 v3, v3, v4
    v_xor_b32 v4, s95, v71
    v_or_b32 v3, v3, v4
    v_cmp_ne_u32 vcc, 0, v3
    s_cbranch_vccz L_qsub_go
    buffer_load_dwordx4 v[56:59], v8, s[40:43], s47 offen offset:0 sc1
    buffer_load_dwordx4 v[60:63], v8, s[40:43], s47 offen offset:1024 sc1
    buffer_load_dwordx4 v[64:67], v8, s[40:43], s47 offen offset:2048 sc1
    buffer_load_dwordx4 v[68:71], v8, s[40:43], s47 offen offset:3072 sc1
    s_lshl_b32 s72, s60, 7
    s_add_u32 s72, s72, 237568
    buffer_load_dword v244, off, s[40:43], s72 sc1
    s_setpc_b64 s[44:45]
L_qsub_go:
    v_lshlrev_b32 v72, 16, v64
    v_and_b32 v73, 0xffff0000, v64
    v_lshlrev_b32 v74, 16, v66
    v_and_b32 v75, 0xffff0000, v66
    v_lshlrev_b32 v76, 16, v68
    v_and_b32 v77, 0xffff0000, v68
    v_lshlrev_b32 v78, 16, v70
    v_and_b32 v79, 0xffff0000, v70
    v_fma_f32 v36, v36, v72, v36
    v_fma_f32 v37, v37, v73, v37
    v_fma_f32 v38, v38, v74, v38
    v_fma_f32 v39, v39, v75, v39
    v_fma_f32 v40, v40, v76, v40
    v_fma_f32 v41, v41, v77, v41
    v_fma_f32 v42, v42, v78, v42
    v_fma_f32 v43, v43, v79, v43
    v_lshlrev_b32 v72, 16, v56
    v_and_b32 v73, 0xffff0000, v56
    v_lshlrev_b32 v74, 16, v58
    v_and_b32 v75, 0xffff0000, v58
    v_lshlrev_b32 v76, 16, v60
    v_and_b32 v77, 0xffff0000, v60
    v_lshlrev_b32 v78, 16, v62
    v_and_b32 v79, 0xffff0000, v62
    v_add_f32 v36, v36, v72
    v_add_f32 v37, v37, v73
    v_add_f32 v38, v38, v74
    v_add_f32 v39, v39, v75
    v_add_f32 v40, v40, v76
    v_add_f32 v41, v41, v77
    v_add_f32 v42, v42, v78
    v_add_f32 v43, v43, v79
    v_cvt_pk_bf16_f32 v32, v36, v37
    v_cvt_pk_bf16_f32 v33, v38, v39
    v_cvt_pk_bf16_f32 v34, v40, v41
    v_cvt_pk_bf16_f32 v35, v42, v43
    s_mul_i32 s72, s64, 1088
    s_add_u32 s72, s72, 98304
    v_add_u32 v3, s72, v2
    ds_write_b128 v3, v[32:35]
    s_waitcnt lgkmcnt(0)
    v_mov_b32 v3, 121348
    v_mov_b32 v4, 1
    s_mov_b64 exec, 1
    ds_add_u32 v3, v4
    s_mov_b64 exec, -1
    s_mov_b32 s73, 1048576
L_mb_2013:
    ds_read_b32 v4, v3
    s_sub_u32 s73, s73, 1
    s_cbranch_scc1 L_mb_2013_out
    s_waitcnt lgkmcnt(0)
    v_readfirstlane_b32 s72, v4
    s_nop 0
    s_cmp_ge_u32 s72, 12
    s_cbranch_scc0 L_mb_2013
L_mb_2013_out:
    ds_read_b64_tr_b16 v[56:57], v52 offset:0
    ds_read_b64_tr_b16 v[58:59], v52 offset:512
    ds_read_b128 v[72:75], v53 offset:0
    ds_read_b64_tr_b16 v[60:61], v52 offset:4096
    ds_read_b64_tr_b16 v[62:63], v52 offset:4608
    ds_read_b128 v[76:79], v53 offset:64
    ds_read_b64_tr_b16 v[64:65], v52 offset:8192
    ds_read_b64_tr_b16 v[66:67], v52 offset:8704
    ds_read_b128 v[80:83], v53 offset:128
    ds_read_b64_tr_b16 v[68:69], v52 offset:12288
    ds_read_b64_tr_b16 v[70:71], v52 offset:12800
    ds_read_b128 v[84:87], v53 offset:192
    ds_read_b64_tr_b16 v[32:33], v52 offset:16384
    ds_read_b64_tr_b16 v[34:35], v52 offset:16896
    ds_read_b128 v[16:19], v53 offset:256
    ds_read_b64_tr_b16 v[36:37], v52 offset:20480
    ds_read_b64_tr_b16 v[38:39], v52 offset:20992
    ds_read_b128 v[20:23], v53 offset:320
    ds_read_b64_tr_b16 v[40:41], v52 offset:24576
    ds_read_b64_tr_b16 v[42:43], v52 offset:25088
    ds_read_b128 v[24:27], v53 offset:384
    ds_read_b64_tr_b16 v[48:49], v52 offset:28672
    ds_read_b64_tr_b16 v[50:51], v52 offset:29184
    ds_read_b128 v[28:31], v53 offset:448
    s_waitcnt lgkmcnt(12)
    v_mfma_f32_16x16x32_bf16 v[44:47], v[56:59], v[72:75], 0
    v_mfma_f32_16x16x32_bf16 v[44:47], v[60:63], v[76:79], v[44:47]
    v_mfma_f32_16x16x32_bf16 v[44:47], v[64:67], v[80:83], v[44:47]
    v_mfma_f32_16x16x32_bf16 v[44:47], v[68:71], v[84:87], v[44:47]
    ds_read_b64_tr_b16 v[56:57], v52 offset:32768
    ds_read_b64_tr_b16 v[58:59], v52 offset:33280
    ds_read_b128 v[72:75], v53 offset:512
    ds_read_b64_tr_b16 v[60:61], v52 offset:36864
    ds_read_b64_tr_b16 v[62:63], v52 offset:37376
    ds_read_b128 v[76:79], v53 offset:576
    ds_read_b64_tr_b16 v[64:65], v52 offset:40960
    ds_read_b64_tr_b16 v[66:67], v52 offset:41472
    ds_read_b128 v[80:83], v53 offset:640
    ds_read_b64_tr_b16 v[68:69], v52 offset:45056
    ds_read_b64_tr_b16 v[70:71], v52 offset:45568
    ds_read_b128 v[84:87], v53 offset:704
    s_waitcnt lgkmcnt(12)
    v_mfma_f32_16x16x32_bf16 v[44:47], v[32:35], v[16:19], v[44:47]
    v_mfma_f32_16x16x32_bf16 v[44:47], v[36:39], v[20:23], v[44:47]
    v_mfma_f32_16x16x32_bf16 v[44:47], v[40:43], v[24:27], v[44:47]
    v_mfma_f32_16x16x32_bf16 v[44:47], v[48:51], v[28:31], v[44:47]
    ds_read_b64_tr_b16 v[32:33], v52 offset:49152
    ds_read_b64_tr_b16 v[34:35], v52 offset:49664
    ds_read_b128 v[16:19], v53 offset:768
    ds_read_b64_tr_b16 v[36:37], v52 offset:53248
    ds_read_b64_tr_b16 v[38:39], v52 offset:53760
    ds_read_b128 v[20:23], v53 offset:832
    ds_read_b64_tr_b16 v[40:41], v52 offset:57344
    ds_read_b64_tr_b16 v[42:43], v52 offset:57856
    ds_read_b128 v[24:27], v53 offset:896
    ds_read_b64_tr_b16 v[48:49], v52 offset:61440
    ds_read_b64_tr_b16 v[50:51], v52 offset:61952
    ds_read_b128 v[28:31], v53 offset:960
    s_waitcnt lgkmcnt(12)
    v_mfma_f32_16x16x32_bf16 v[44:47], v[56:59], v[72:75], v[44:47]
    v_mfma_f32_16x16x32_bf16 v[44:47], v[60:63], v[76:79], v[44:47]
    v_mfma_f32_16x16x32_bf16 v[44:47], v[64:67], v[80:83], v[44:47]
    v_mfma_f32_16x16x32_bf16 v[44:47], v[68:71], v[84:87], v[44:47]
    s_waitcnt lgkmcnt(9)
    v_mfma_f32_16x16x32_bf16 v[44:47], v[32:35], v[16:19], v[44:47]
    s_waitcnt lgkmcnt(6)
    v_mfma_f32_16x16x32_bf16 v[44:47], v[36:39], v[20:23], v[44:47]
    s_waitcnt lgkmcnt(3)
    v_mfma_f32_16x16x32_bf16 v[44:47], v[40:43], v[24:27], v[44:47]
    s_waitcnt lgkmcnt(0)
    v_mfma_f32_16x16x32_bf16 v[44:47], v[48:51], v[28:31], v[44:47]
    s_nop 7
    v_cvt_pk_bf16_f32 v48, v44, v45
    v_cvt_pk_bf16_f32 v49, v46, v47
    v_min_u32 v48, -2, v48
    v_min_u32 v49, -2, v49
    s_mov_b32 exec_lo, 0x000f000f
    s_mov_b32 exec_hi, 0x000f000f
    v_readfirstlane_b32 s72, v244
    s_nop 0
    s_xor_b32 s72, s72, s95
    s_cmp_eq_u32 s72, 1
    s_cbranch_scc0 L_qsub_wt
    buffer_store_dwordx2 v[48:49], v54, s[40:43], s74 offen
    s_branch L_qsub_st
L_qsub_wt:
    buffer_store_dwordx2 v[48:49], v54, s[40:43], s74 offen sc1
L_qsub_st:
    s_mov_b64 exec, -1
    s_mov_b32 s46, 0
    s_nop 1
    s_setpc_b64 s[44:45]
L_fl_13_spin:
    s_mov_b32 s71, 0
L_fl_13_loop:
    s_sleep 4
    buffer_load_dword v240, v242, s[40:43], 0 offen sc1
    s_waitcnt vmcnt(0)
    v_xor_b32 v3, s95, v240
    v_cmp_le_u32 vcc, 8, v3
    s_cbranch_vccz L_fl_13_ok
    s_add_u32 s71, s71, 1
    s_cmp_lt_u32 s71, 200000
    s_cbranch_scc1 L_fl_13_loop
    s_branch L_fl_13_ok
L_st_14_slow:
    buffer_store_dwordx4 v[16:19], v2, s[40:43], s72 offen sc1
    s_branch L_st_14_done
L_pq_15_spin:
    s_mov_b32 s71, 0
L_pq_15_loop:
    buffer_load_dwordx4 v[12:15], v3, s[40:43], s73 offen sc1
    s_waitcnt vmcnt(0)
    v_max3_u32 v4, v12, v13, v14
    v_max_u32 v4, v15, v4
    v_cmp_eq_u32 vcc, -1, v4
    s_cbranch_vccz L_pq_15_ok
    s_add_u32 s71, s71, 1
    s_cmp_lt_u32 s71, 200000
    s_cbranch_scc1 L_pq_15_loop
    s_branch L_pq_15_ok
L_st_16_slow:
    buffer_store_dwordx4 v[16:19], v4, s[40:43], s72 offen sc1
    s_branch L_st_16_done
L_vx_7018_late:
    s_mov_b32 s84, 1
    s_branch L_vx_7018_go
L_vexit5:
    s_waitcnt vmcnt(4)
    v_perm_b32 v208, v100, v96, s80
    v_perm_b32 v209, v108, v104, s80
    v_perm_b32 v210, v100, v96, s81
    v_perm_b32 v211, v108, v104, s81
    v_mfma_f32_16x16x16_bf16 v[176:179], v[208:209], v[232:233], v[176:179]
    v_perm_b32 v212, v101, v97, s80
    v_perm_b32 v213, v109, v105, s80
    v_mfma_f32_16x16x16_bf16 v[180:183], v[210:211], v[232:233], v[180:183]
    v_perm_b32 v214, v101, v97, s81
    v_perm_b32 v215, v109, v105, s81
    v_mfma_f32_16x16x16_bf16 v[184:187], v[212:213], v[232:233], v[184:187]
    v_perm_b32 v216, v102, v98, s80
    v_perm_b32 v217, v110, v106, s80
    v_mfma_f32_16x16x16_bf16 v[188:191], v[214:215], v[232:233], v[188:191]
    v_perm_b32 v218, v102, v98, s81
    v_perm_b32 v219, v110, v106, s81
    v_mfma_f32_16x16x16_bf16 v[192:195], v[216:217], v[232:233], v[192:195]
    v_perm_b32 v220, v103, v99, s80
    v_perm_b32 v221, v111, v107, s80
    v_mfma_f32_16x16x16_bf16 v[196:199], v[218:219], v[232:233], v[196:199]
    v_perm_b32 v222, v103, v99, s81
    v_perm_b32 v223, v111, v107, s81
    v_mfma_f32_16x16x16_bf16 v[200:203], v[220:221], v[232:233], v[200:203]
    s_nop 0
    v_mfma_f32_16x16x16_bf16 v[204:207], v[222:223], v[232:233], v[204:207]
    s_waitcnt vmcnt(4)
    v_xor_b32 v3, s95, v21
    v_bitop3_b32 v3, v3, v23, s95 bitop3:0xf6
    v_bitop3_b32 v3, v3, v15, s95 bitop3:0xf6
    v_cmp_ne_u32 vcc, 0, v3
    s_cbranch_vccnz L_vx_7018_late
    v_max_f32_dpp v10, v20, v20 row_ror:4 row_mask:0xf bank_mask:0xf
    s_nop 1
    v_max_f32_dpp v10, v10, v10 row_ror:8 row_mask:0xf bank_mask:0xf
    v_mov_b32 v3, v10
    s_nop 1
    v_permlane16_swap_b32 v10, v3
    v_max_f32 v10, v10, v3
    v_sub_f32 v20, v20, v10
    v_exp_f32 v20, v20
    s_nop 0
    v_mul_f32 v22, v22, v20
    s_nop 1
    v_add_f32_dpp v22, v22, v22 row_ror:4 row_mask:0xf bank_mask:0xf
    s_nop 1
    v_add_f32_dpp v22, v22, v22 row_ror:8 row_mask:0xf bank_mask:0xf
    v_mov_b32 v3, v22
    s_nop 1
    v_permlane16_swap_b32 v22, v3
    v_add_f32 v22, v22, v3
    v_sub_f32 v11, v9, v10
    v_exp_f32 v11, v11
    v_rcp_f32 v22, v22
    s_nop 0
    v_mul_f32 v11, v11, v22
L_vx_7018_go:
    s_waitcnt vmcnt(0)
    v_perm_b32 v208, v116, v112, s80
    v_perm_b32 v209, v124, v120, s80
    v_perm_b32 v210, v116, v112, s81
    v_perm_b32 v211, v124, v120, s81
    v_mfma_f32_16x16x16_bf16 v[176:179], v[208:209], v[234:235], v[176:179]
    v_perm_b32 v212, v117, v113, s80
    v_perm_b32 v213, v125, v121, s80
    v_mfma_f32_16x16x16_bf16 v[180:183], v[210:211], v[234:235], v[180:183]
    v_perm_b32 v214, v117, v113, s81
    v_perm_b32 v215, v125, v121, s81
    v_mfma_f32_16x16x16_bf16 v[184:187], v[212:213], v[234:235], v[184:187]
    v_perm_b32 v216, v118, v114, s80
    v_perm_b32 v217, v126, v122, s80
    v_mfma_f32_16x16x16_bf16 v[188:191], v[214:215], v[234:235], v[188:191]
    v_perm_b32 v218, v118, v114, s81
    v_perm_b32 v219, v126, v122, s81
    v_mfma_f32_16x16x16_bf16 v[192:195], v[216:217], v[234:235], v[192:195]
    v_perm_b32 v220, v119, v115, s80
    v_perm_b32 v221, v127, v123, s80
    v_mfma_f32_16x16x16_bf16 v[196:199], v[218:219], v[234:235], v[196:199]
    v_perm_b32 v222, v119, v115, s81
    v_perm_b32 v223, v127, v123, s81
    v_mfma_f32_16x16x16_bf16 v[200:203], v[220:221], v[234:235], v[200:203]
    s_nop 0
    v_mfma_f32_16x16x16_bf16 v[204:207], v[222:223], v[234:235], v[204:207]
    s_branch L_pv_done
L_vx_9019_late:
    s_mov_b32 s84, 1
    s_branch L_vx_9019_go
L_vexit6:
    s_waitcnt vmcnt(4)
    v_perm_b32 v208, v116, v112, s80
    v_perm_b32 v209, v124, v120, s80
    v_perm_b32 v210, v116, v112, s81
    v_perm_b32 v211, v124, v120, s81
    v_mfma_f32_16x16x16_bf16 v[176:179], v[208:209], v[234:235], v[176:179]
    v_perm_b32 v212, v117, v113, s80
    v_perm_b32 v213, v125, v121, s80
    v_mfma_f32_16x16x16_bf16 v[180:183], v[210:211], v[234:235], v[180:183]
    v_perm_b32 v214, v117, v113, s81
    v_perm_b32 v215, v125, v121, s81
    v_mfma_f32_16x16x16_bf16 v[184:187], v[212:213], v[234:235], v[184:187]
    v_perm_b32 v216, v118, v114, s80
    v_perm_b32 v217, v126, v122, s80
    v_mfma_f32_16x16x16_bf16 v[188:191], v[214:215], v[234:235], v[188:191]
    v_perm_b32 v218, v118, v114, s81
    v_perm_b32 v219, v126, v122, s81
    v_mfma_f32_16x16x16_bf16 v[192:195], v[216:217], v[234:235], v[192:195]
    v_perm_b32 v220, v119, v115, s80
    v_perm_b32 v221, v127, v123, s80
    v_mfma_f32_16x16x16_bf16 v[196:199], v[218:219], v[234:235], v[196:199]
    v_perm_b32 v222, v119, v115, s81
    v_perm_b32 v223, v127, v123, s81
    v_mfma_f32_16x16x16_bf16 v[200:203], v[220:221], v[234:235], v[200:203]
    s_nop 0
    v_mfma_f32_16x16x16_bf16 v[204:207], v[222:223], v[234:235], v[204:207]
    s_waitcnt vmcnt(4)
    v_xor_b32 v3, s95, v21
    v_bitop3_b32 v3, v3, v23, s95 bitop3:0xf6
    v_bitop3_b32 v3, v3, v15, s95 bitop3:0xf6
    v_cmp_ne_u32 vcc, 0, v3
    s_cbranch_vccnz L_vx_9019_late
    v_max_f32_dpp v10, v20, v20 row_ror:4 row_mask:0xf bank_mask:0xf
    s_nop 1
    v_max_f32_dpp v10, v10, v10 row_ror:8 row_mask:0xf bank_mask:0xf
    v_mov_b32 v3, v10
    s_nop 1
    v_permlane16_swap_b32 v10, v3
    v_max_f32 v10, v10, v3
    v_sub_f32 v20, v20, v10
    v_exp_f32 v20, v20
    s_nop 0
    v_mul_f32 v22, v22, v20
    s_nop 1
    v_add_f32_dpp v22, v22, v22 row_ror:4 row_mask:0xf bank_mask:0xf
    s_nop 1
    v_add_f32_dpp v22, v22, v22 row_ror:8 row_mask:0xf bank_mask:0xf
    v_mov_b32 v3, v22
    s_nop 1
    v_permlane16_swap_b32 v22, v3
    v_add_f32 v22, v22, v3
    v_sub_f32 v11, v9, v10
    v_exp_f32 v11, v11
    v_rcp_f32 v22, v22
    s_nop 0
    v_mul_f32 v11, v11, v22
L_vx_9019_go:
    s_waitcnt vmcnt(0)
    v_perm_b32 v208, v132, v128, s80
    v_perm_b32 v209, v140, v136, s80
    v_perm_b32 v210, v132, v128, s81
    v_perm_b32 v211, v140, v136, s81
    v_mfma_f32_16x16x16_bf16 v[176:179], v[208:209], v[236:237], v[176:179]
    v_perm_b32 v212, v133, v129, s80
    v_perm_b32 v213, v141, v137, s80
    v_mfma_f32_16x16x16_bf16 v[180:183], v[210:211], v[236:237], v[180:183]
    v_perm_b32 v214, v133, v129, s81
    v_perm_b32 v215, v141, v137, s81
    v_mfma_f32_16x16x16_bf16 v[184:187], v[212:213], v[236:237], v[184:187]
    v_perm_b32 v216, v134, v130, s80
    v_perm_b32 v217, v142, v138, s80
    v_mfma_f32_16x16x16_bf16 v[188:191], v[214:215], v[236:237], v[188:191]
    v_perm_b32 v218, v134, v130, s81
    v_perm_b32 v219, v142, v138, s81
    v_mfma_f32_16x16x16_bf16 v[192:195], v[216:217], v[236:237], v[192:195]
    v_perm_b32 v220, v135, v131, s80
    v_perm_b32 v221, v143, v139, s80
    v_mfma_f32_16x16x16_bf16 v[196:199], v[218:219], v[236:237], v[196:199]
    v_perm_b32 v222, v135, v131, s81
    v_perm_b32 v223, v143, v139, s81
    v_mfma_f32_16x16x16_bf16 v[200:203], v[220:221], v[236:237], v[200:203]
    s_nop 0
    v_mfma_f32_16x16x16_bf16 v[204:207], v[222:223], v[236:237], v[204:207]
    s_branch L_pv_done
L_vx_11020_late:
    s_mov_b32 s84, 1
    s_branch L_vx_11020_go
L_vexit7:
    s_waitcnt vmcnt(4)
    v_perm_b32 v208, v132, v128, s80
    v_perm_b32 v209, v140, v136, s80
    v_perm_b32 v210, v132, v128, s81
    v_perm_b32 v211, v140, v136, s81
    v_mfma_f32_16x16x16_bf16 v[176:179], v[208:209], v[236:237], v[176:179]
    v_perm_b32 v212, v133, v129, s80
    v_perm_b32 v213, v141, v137, s80
    v_mfma_f32_16x16x16_bf16 v[180:183], v[210:211], v[236:237], v[180:183]
    v_perm_b32 v214, v133, v129, s81
    v_perm_b32 v215, v141, v137, s81
    v_mfma_f32_16x16x16_bf16 v[184:187], v[212:213], v[236:237], v[184:187]
    v_perm_b32 v216, v134, v130, s80
    v_perm_b32 v217, v142, v138, s80
    v_mfma_f32_16x16x16_bf16 v[188:191], v[214:215], v[236:237], v[188:191]
    v_perm_b32 v218, v134, v130, s81
    v_perm_b32 v219, v142, v138, s81
    v_mfma_f32_16x16x16_bf16 v[192:195], v[216:217], v[236:237], v[192:195]
    v_perm_b32 v220, v135, v131, s80
    v_perm_b32 v221, v143, v139, s80
    v_mfma_f32_16x16x16_bf16 v[196:199], v[218:219], v[236:237], v[196:199]
    v_perm_b32 v222, v135, v131, s81
    v_perm_b32 v223, v143, v139, s81
    v_mfma_f32_16x16x16_bf16 v[200:203], v[220:221], v[236:237], v[200:203]
    s_nop 0
    v_mfma_f32_16x16x16_bf16 v[204:207], v[222:223], v[236:237], v[204:207]
    s_waitcnt vmcnt(4)
    v_xor_b32 v3, s95, v21
    v_bitop3_b32 v3, v3, v23, s95 bitop3:0xf6
    v_bitop3_b32 v3, v3, v15, s95 bitop3:0xf6
    v_cmp_ne_u32 vcc, 0, v3
    s_cbranch_vccnz L_vx_11020_late
    v_max_f32_dpp v10, v20, v20 row_ror:4 row_mask:0xf bank_mask:0xf
    s_nop 1
    v_max_f32_dpp v10, v10, v10 row_ror:8 row_mask:0xf bank_mask:0xf
    v_mov_b32 v3, v10
    s_nop 1
    v_permlane16_swap_b32 v10, v3
    v_max_f32 v10, v10, v3
    v_sub_f32 v20, v20, v10
    v_exp_f32 v20, v20
    s_nop 0
    v_mul_f32 v22, v22, v20
    s_nop 1
    v_add_f32_dpp v22, v22, v22 row_ror:4 row_mask:0xf bank_mask:0xf
    s_nop 1
    v_add_f32_dpp v22, v22, v22 row_ror:8 row_mask:0xf bank_mask:0xf
    v_mov_b32 v3, v22
    s_nop 1
    v_permlane16_swap_b32 v22, v3
    v_add_f32 v22, v22, v3
    v_sub_f32 v11, v9, v10
    v_exp_f32 v11, v11
    v_rcp_f32 v22, v22
    s_nop 0
    v_mul_f32 v11, v11, v22
L_vx_11020_go:
    s_waitcnt vmcnt(0)
    v_perm_b32 v208, v148, v144, s80
    v_perm_b32 v209, v156, v152, s80
    v_perm_b32 v210, v148, v144, s81
    v_perm_b32 v211, v156, v152, s81
    v_mfma_f32_16x16x16_bf16 v[176:179], v[208:209], v[238:239], v[176:179]
    v_perm_b32 v212, v149, v145, s80
    v_perm_b32 v213, v157, v153, s80
    v_mfma_f32_16x16x16_bf16 v[180:183], v[210:211], v[238:239], v[180:183]
    v_perm_b32 v214, v149, v145, s81
    v_perm_b32 v215, v157, v153, s81
    v_mfma_f32_16x16x16_bf16 v[184:187], v[212:213], v[238:239], v[184:187]
    v_perm_b32 v216, v150, v146, s80
    v_perm_b32 v217, v158, v154, s80
    v_mfma_f32_16x16x16_bf16 v[188:191], v[214:215], v[238:239], v[188:191]
    v_perm_b32 v218, v150, v146, s81
    v_perm_b32 v219, v158, v154, s81
    v_mfma_f32_16x16x16_bf16 v[192:195], v[216:217], v[238:239], v[192:195]
    v_perm_b32 v220, v151, v147, s80
    v_perm_b32 v221, v159, v155, s80
    v_mfma_f32_16x16x16_bf16 v[196:199], v[218:219], v[238:239], v[196:199]
    v_perm_b32 v222, v151, v147, s81
    v_perm_b32 v223, v159, v155, s81
    v_mfma_f32_16x16x16_bf16 v[200:203], v[220:221], v[238:239], v[200:203]
    s_nop 0
    v_mfma_f32_16x16x16_bf16 v[204:207], v[222:223], v[238:239], v[204:207]
    s_branch L_pv_done
L_vx_21_late:
    s_mov_b32 s84, 1
    s_branch L_vx_21_go
L_mlw_spin:
    s_mov_b32 s71, 0
L_mlw_loop:
    buffer_load_dwordx4 v[20:23], v241, s[40:43], s77 offen sc1
    buffer_load_dword v15, v242, s[40:43], 0 offen sc1
    s_waitcnt vmcnt(0)
    v_xor_b32 v3, s95, v21
    v_bitop3_b32 v3, v3, v23, s95 bitop3:0xf6
    v_bitop3_b32 v3, v3, v15, s95 bitop3:0xf6
    v_cmp_ne_u32 vcc, 0, v3
    s_cbranch_vccz L_mlw_ok
    s_add_u32 s71, s71, 1
    s_cmp_lt_u32 s71, 200000
    s_cbranch_scc1 L_mlw_loop
    s_branch L_mlw_ok
L_mlw_ok:
    v_max_f32_dpp v10, v20, v20 row_ror:4 row_mask:0xf bank_mask:0xf
    s_nop 1
    v_max_f32_dpp v10, v10, v10 row_ror:8 row_mask:0xf bank_mask:0xf
    v_mov_b32 v3, v10
    s_nop 1
    v_permlane16_swap_b32 v10, v3
    v_max_f32 v10, v10, v3
    v_sub_f32 v20, v20, v10
    v_exp_f32 v20, v20
    s_nop 0
    v_mul_f32 v22, v22, v20
    s_nop 1
    v_add_f32_dpp v22, v22, v22 row_ror:4 row_mask:0xf bank_mask:0xf
    s_nop 1
    v_add_f32_dpp v22, v22, v22 row_ror:8 row_mask:0xf bank_mask:0xf
    v_mov_b32 v3, v22
    s_nop 1
    v_permlane16_swap_b32 v22, v3
    v_add_f32 v22, v22, v3
    v_sub_f32 v11, v9, v10
    v_exp_f32 v11, v11
    v_rcp_f32 v22, v22
    s_nop 0
    v_mul_f32 v11, v11, v22
    s_branch L_ml_fin
L_st_22_slow:
    buffer_store_dword v32, v7, s[40:43], s76 offen sc1
    s_branch L_st_22_done
L_po_23_s0:
    s_mov_b64 exec, vcc
    buffer_load_dwordx4 v[32:35], v2, s[40:43], s76 offen offset:0 sc1
    buffer_load_dwordx4 v[36:39], v2, s[40:43], s76 offen offset:1024 sc1
    s_mov_b64 exec, -1
    s_waitcnt vmcnt(2)
    v_max3_u32 v4, v40, v41, v42
    v_max3_u32 v4, v43, v44, v4
    v_max3_u32 v4, v45, v46, v4
    v_max_u32 v4, v47, v4
    v_cmp_eq_u32 s[24:25], -1, v4
    s_branch L_po_23_w0
L_po_23_l0:
    s_mov_b64 exec, vcc
    buffer_load_dwordx4 v[32:35], v2, s[40:43], s76 offen offset:0 sc1
    buffer_load_dwordx4 v[36:39], v2, s[40:43], s76 offen offset:1024 sc1
    s_mov_b64 exec, -1
L_po_23_w0:
    s_add_u32 s71, s71, 1
    s_cmp_ge_u32 s71, 200000
    s_waitcnt vmcnt(0)
    s_cbranch_scc1 L_po_23_r0
    v_max3_u32 v3, v32, v33, v34
    v_max3_u32 v3, v35, v36, v3
    v_max3_u32 v3, v37, v38, v3
    v_max_u32 v3, v39, v3
    v_cmp_eq_u32 vcc, -1, v3
    s_cbranch_vccnz L_po_23_l0
    s_cmp_eq_u64 s[24:25], 0
    s_cbranch_scc1 L_po_23_r0
    buffer_load_dwordx4 v[40:43], v2, s[40:43], s76 offen offset:2048 sc1
    buffer_load_dwordx4 v[44:47], v2, s[40:43], s76 offen offset:3072 sc1
    s_branch L_po_23_r0
L_po_23_s1:
    s_mov_b64 exec, vcc
    buffer_load_dwordx4 v[40:43], v2, s[40:43], s76 offen offset:2048 sc1
    buffer_load_dwordx4 v[44:47], v2, s[40:43], s76 offen offset:3072 sc1
    s_mov_b64 exec, -1
L_po_23_w1:
    s_add_u32 s71, s71, 1
    s_cmp_ge_u32 s71, 200000
    s_waitcnt vmcnt(0)
    s_cbranch_scc1 L_po_23_r1
    v_max3_u32 v3, v40, v41, v42
    v_max3_u32 v3, v43, v44, v3
    v_max3_u32 v3, v45, v46, v3
    v_max_u32 v3, v47, v3
    v_cmp_eq_u32 vcc, -1, v3
    s_cbranch_vccnz L_po_23_s1
    s_branch L_po_23_r1
L_o_hi:
    s_branch L_fin
L_pmod_24_spin:
    s_mov_b32 s71, 0
L_pmod_24_loop:
    buffer_load_dwordx4 v[28:31], v2, s[40:43], s73 offen offset:0 sc1
    buffer_load_dwordx4 v[244:247], v2, s[40:43], s73 offen offset:1024 sc1
    buffer_load_dwordx4 v[248:251], v2, s[40:43], s73 offen offset:2048 sc1
    s_waitcnt vmcnt(0)
    v_max3_u32 v3, v28, v29, v30
    v_max3_u32 v3, v31, v244, v3
    v_max3_u32 v3, v245, v246, v3
    v_max3_u32 v3, v247, v248, v3
    v_max3_u32 v3, v249, v250, v3
    v_max_u32 v3, v251, v3
    v_cmp_eq_u32 vcc, -1, v3
    s_cbranch_vccz L_pmod_24_ok
    s_add_u32 s71, s71, 1
    s_cmp_lt_u32 s71, 200000
    s_cbranch_scc1 L_pmod_24_loop
    s_branch L_pmod_24_ok
L_px_25_s0:
    s_mov_b64 exec, vcc
    buffer_load_dwordx4 v[176:179], v2, s[40:43], s6 offen sc1
    s_mov_b64 exec, -1
    s_waitcnt vmcnt(1)
    v_max3_u32 v4, v180, v181, v182
    v_max3_u32 v4, v183, v184, v4
    v_max3_u32 v4, v185, v186, v4
    v_max3_u32 v4, v187, v188, v4
    v_max3_u32 v4, v189, v190, v4
    v_max3_u32 v4, v191, v192, v4
    v_max3_u32 v4, v193, v194, v4
    v_max3_u32 v4, v195, v196, v4
    v_max3_u32 v4, v197, v198, v4
    v_max3_u32 v4, v199, v200, v4
    v_max3_u32 v4, v201, v202, v4
    v_max3_u32 v4, v203, v204, v4
    v_max3_u32 v4, v205, v206, v4
    v_max_u32 v4, v207, v4
    v_cmp_eq_u32 s[24:25], -1, v4
    s_branch L_px_25_w0
L_px_25_l0:
    s_mov_b64 exec, vcc
    buffer_load_dwordx4 v[176:179], v2, s[40:43], s6 offen sc1
    s_mov_b64 exec, -1
L_px_25_w0:
    s_add_u32 s71, s71, 1
    s_cmp_ge_u32 s71, 200000
    s_waitcnt vmcnt(0)
    s_cbranch_scc1 L_px_25_r0
    v_max3_u32 v3, v176, v177, v178
    v_max_u32 v3, v179, v3
    v_cmp_eq_u32 vcc, -1, v3
    s_cbranch_vccnz L_px_25_l0
    s_cmp_eq_u64 s[24:25], 0
    s_cbranch_scc1 L_px_25_r0
    buffer_load_dwordx4 v[180:183], v2, s[40:43], s7 offen sc1
    buffer_load_dwordx4 v[184:187], v2, s[40:43], s8 offen sc1
    buffer_load_dwordx4 v[188:191], v2, s[40:43], s9 offen sc1
    buffer_load_dwordx4 v[192:195], v2, s[40:43], s10 offen sc1
    buffer_load_dwordx4 v[196:199], v2, s[40:43], s11 offen sc1
    buffer_load_dwordx4 v[200:203], v2, s[40:43], s12 offen sc1
    buffer_load_dwordx4 v[204:207], v2, s[40:43], s13 offen sc1
    s_branch L_px_25_r0
L_px_25_s1:
    s_mov_b64 exec, vcc
    buffer_load_dwordx4 v[180:183], v2, s[40:43], s7 offen sc1
    s_mov_b64 exec, -1
    s_waitcnt vmcnt(1)
    v_max3_u32 v4, v184, v185, v186
    v_max3_u32 v4, v187, v188, v4
    v_max3_u32 v4, v189, v190, v4
    v_max3_u32 v4, v191, v192, v4
    v_max3_u32 v4, v193, v194, v4
    v_max3_u32 v4, v195, v196, v4
    v_max3_u32 v4, v197, v198, v4
    v_max3_u32 v4, v199, v200, v4
    v_max3_u32 v4, v201, v202, v4
    v_max3_u32 v4, v203, v204, v4
    v_max3_u32 v4, v205, v206, v4
    v_max_u32 v4, v207, v4
    v_cmp_eq_u32 s[24:25], -1, v4
    s_branch L_px_25_w1
L_px_25_l1:
    s_mov_b64 exec, vcc
    buffer_load_dwordx4 v[180:183], v2, s[40:43], s7 offen sc1
    s_mov_b64 exec, -1
L_px_25_w1:
    s_add_u32 s71, s71, 1
    s_cmp_ge_u32 s71, 200000
    s_waitcnt vmcnt(0)
    s_cbranch_scc1 L_px_25_r1
    v_max3_u32 v3, v180, v181, v182
    v_max_u32 v3, v183, v3
    v_cmp_eq_u32 vcc, -1, v3
    s_cbranch_vccnz L_px_25_l1
    s_cmp_eq_u64 s[24:25], 0
    s_cbranch_scc1 L_px_25_r1
    buffer_load_dwordx4 v[184:187], v2, s[40:43], s8 offen sc1
    buffer_load_dwordx4 v[188:191], v2, s[40:43], s9 offen sc1
    buffer_load_dwordx4 v[192:195], v2, s[40:43], s10 offen sc1
    buffer_load_dwordx4 v[196:199], v2, s[40:43], s11 offen sc1
    buffer_load_dwordx4 v[200:203], v2, s[40:43], s12 offen sc1
    buffer_load_dwordx4 v[204:207], v2, s[40:43], s13 offen sc1
    s_branch L_px_25_r1
L_px_25_s2:
    s_mov_b64 exec, vcc
    buffer_load_dwordx4 v[184:187], v2, s[40:43], s8 offen sc1
    s_mov_b64 exec, -1
    s_waitcnt vmcnt(1)
    v_max3_u32 v4, v188, v189, v190
    v_max3_u32 v4, v191, v192, v4
    v_max3_u32 v4, v193, v194, v4
    v_max3_u32 v4, v195, v196, v4
    v_max3_u32 v4, v197, v198, v4
    v_max3_u32 v4, v199, v200, v4
    v_max3_u32 v4, v201, v202, v4
    v_max3_u32 v4, v203, v204, v4
    v_max3_u32 v4, v205, v206, v4
    v_max_u32 v4, v207, v4
    v_cmp_eq_u32 s[24:25], -1, v4
    s_branch L_px_25_w2
L_px_25_l2:
    s_mov_b64 exec, vcc
    buffer_load_dwordx4 v[184:187], v2, s[40:43], s8 offen sc1
    s_mov_b64 exec, -1
L_px_25_w2:
    s_add_u32 s71, s71, 1
    s_cmp_ge_u32 s71, 200000
    s_waitcnt vmcnt(0)
    s_cbranch_scc1 L_px_25_r2
    v_max3_u32 v3, v184, v185, v186
    v_max_u32 v3, v187, v3
    v_cmp_eq_u32 vcc, -1, v3
    s_cbranch_vccnz L_px_25_l2
    s_cmp_eq_u64 s[24:25], 0
    s_cbranch_scc1 L_px_25_r2
    buffer_load_dwordx4 v[188:191], v2, s[40:43], s9 offen sc1
    buffer_load_dwordx4 v[192:195], v2, s[40:43], s10 offen sc1
    buffer_load_dwordx4 v[196:199], v2, s[40:43], s11 offen sc1
    buffer_load_dwordx4 v[200:203], v2, s[40:43], s12 offen sc1
    buffer_load_dwordx4 v[204:207], v2, s[40:43], s13 offen sc1
    s_branch L_px_25_r2
L_px_25_s3:
    s_mov_b64 exec, vcc
    buffer_load_dwordx4 v[188:191], v2, s[40:43], s9 offen sc1
    s_mov_b64 exec, -1
    s_waitcnt vmcnt(1)
    v_max3_u32 v4, v192, v193, v194
    v_max3_u32 v4, v195, v196, v4
    v_max3_u32 v4, v197, v198, v4
    v_max3_u32 v4, v199, v200, v4
    v_max3_u32 v4, v201, v202, v4
    v_max3_u32 v4, v203, v204, v4
    v_max3_u32 v4, v205, v206, v4
    v_max_u32 v4, v207, v4
    v_cmp_eq_u32 s[24:25], -1, v4
    s_branch L_px_25_w3
L_px_25_l3:
    s_mov_b64 exec, vcc
    buffer_load_dwordx4 v[188:191], v2, s[40:43], s9 offen sc1
    s_mov_b64 exec, -1
L_px_25_w3:
    s_add_u32 s71, s71, 1
    s_cmp_ge_u32 s71, 200000
    s_waitcnt vmcnt(0)
    s_cbranch_scc1 L_px_25_r3
    v_max3_u32 v3, v188, v189, v190
    v_max_u32 v3, v191, v3
    v_cmp_eq_u32 vcc, -1, v3
    s_cbranch_vccnz L_px_25_l3
    s_cmp_eq_u64 s[24:25], 0
    s_cbranch_scc1 L_px_25_r3
    buffer_load_dwordx4 v[192:195], v2, s[40:43], s10 offen sc1
    buffer_load_dwordx4 v[196:199], v2, s[40:43], s11 offen sc1
    buffer_load_dwordx4 v[200:203], v2, s[40:43], s12 offen sc1
    buffer_load_dwordx4 v[204:207], v2, s[40:43], s13 offen sc1
    s_branch L_px_25_r3
L_px_25_s4:
    s_mov_b64 exec, vcc
    buffer_load_dwordx4 v[192:195], v2, s[40:43], s10 offen sc1
    s_mov_b64 exec, -1
    s_waitcnt vmcnt(1)
    v_max3_u32 v4, v196, v197, v198
    v_max3_u32 v4, v199, v200, v4
    v_max3_u32 v4, v201, v202, v4
    v_max3_u32 v4, v203, v204, v4
    v_max3_u32 v4, v205, v206, v4
    v_max_u32 v4, v207, v4
    v_cmp_eq_u32 s[24:25], -1, v4
    s_branch L_px_25_w4
L_px_25_l4:
    s_mov_b64 exec, vcc
    buffer_load_dwordx4 v[192:195], v2, s[40:43], s10 offen sc1
    s_mov_b64 exec, -1
L_px_25_w4:
    s_add_u32 s71, s71, 1
    s_cmp_ge_u32 s71, 200000
    s_waitcnt vmcnt(0)
    s_cbranch_scc1 L_px_25_r4
    v_max3_u32 v3, v192, v193, v194
    v_max_u32 v3, v195, v3
    v_cmp_eq_u32 vcc, -1, v3
    s_cbranch_vccnz L_px_25_l4
    s_cmp_eq_u64 s[24:25], 0
    s_cbranch_scc1 L_px_25_r4
    buffer_load_dwordx4 v[196:199], v2, s[40:43], s11 offen sc1
    buffer_load_dwordx4 v[200:203], v2, s[40:43], s12 offen sc1
    buffer_load_dwordx4 v[204:207], v2, s[40:43], s13 offen sc1
    s_branch L_px_25_r4
L_px_25_s5:
    s_mov_b64 exec, vcc
    buffer_load_dwordx4 v[196:199], v2, s[40:43], s11 offen sc1
    s_mov_b64 exec, -1
    s_waitcnt vmcnt(1)
    v_max3_u32 v4, v200, v201, v202
    v_max3_u32 v4, v203, v204, v4
    v_max3_u32 v4, v205, v206, v4
    v_max_u32 v4, v207, v4
    v_cmp_eq_u32 s[24:25], -1, v4
    s_branch L_px_25_w5
L_px_25_l5:
    s_mov_b64 exec, vcc
    buffer_load_dwordx4 v[196:199], v2, s[40:43], s11 offen sc1
    s_mov_b64 exec, -1
L_px_25_w5:
    s_add_u32 s71, s71, 1
    s_cmp_ge_u32 s71, 200000
    s_waitcnt vmcnt(0)
    s_cbranch_scc1 L_px_25_r5
    v_max3_u32 v3, v196, v197, v198
    v_max_u32 v3, v199, v3
    v_cmp_eq_u32 vcc, -1, v3
    s_cbranch_vccnz L_px_25_l5
    s_cmp_eq_u64 s[24:25], 0
    s_cbranch_scc1 L_px_25_r5
    buffer_load_dwordx4 v[200:203], v2, s[40:43], s12 offen sc1
    buffer_load_dwordx4 v[204:207], v2, s[40:43], s13 offen sc1
    s_branch L_px_25_r5
L_px_25_s6:
    s_mov_b64 exec, vcc
    buffer_load_dwordx4 v[200:203], v2, s[40:43], s12 offen sc1
    s_mov_b64 exec, -1
    s_waitcnt vmcnt(1)
    v_max3_u32 v4, v204, v205, v206
    v_max_u32 v4, v207, v4
    v_cmp_eq_u32 s[24:25], -1, v4
    s_branch L_px_25_w6
L_px_25_l6:
    s_mov_b64 exec, vcc
    buffer_load_dwordx4 v[200:203], v2, s[40:43], s12 offen sc1
    s_mov_b64 exec, -1
L_px_25_w6:
    s_add_u32 s71, s71, 1
    s_cmp_ge_u32 s71, 200000
    s_waitcnt vmcnt(0)
    s_cbranch_scc1 L_px_25_r6
    v_max3_u32 v3, v200, v201, v202
    v_max_u32 v3, v203, v3
    v_cmp_eq_u32 vcc, -1, v3
    s_cbranch_vccnz L_px_25_l6
    s_cmp_eq_u64 s[24:25], 0
    s_cbranch_scc1 L_px_25_r6
    buffer_load_dwordx4 v[204:207], v2, s[40:43], s13 offen sc1
    s_branch L_px_25_r6
L_px_25_s7:
    s_mov_b64 exec, vcc
    buffer_load_dwordx4 v[204:207], v2, s[40:43], s13 offen sc1
    s_mov_b64 exec, -1
L_px_25_w7:
    s_add_u32 s71, s71, 1
    s_cmp_ge_u32 s71, 200000
    s_waitcnt vmcnt(0)
    s_cbranch_scc1 L_px_25_r7
    v_max3_u32 v3, v204, v205, v206
    v_max_u32 v3, v207, v3
    v_cmp_eq_u32 vcc, -1, v3
    s_cbranch_vccnz L_px_25_s7
    s_branch L_px_25_r7
L_pr0_26_spin:
    s_mov_b32 s71, 0
L_pr0_26_loop:
    buffer_load_dword v25, v5, s[40:43], s73 offen sc1
    buffer_load_dword v26, v5, s[40:43], s73 offen offset:3072 sc1
    s_waitcnt vmcnt(0)
    v_max_u32 v3, v25, v26
    v_cmp_eq_u32 vcc, -1, v3
    s_cbranch_vccz L_pr0_26_ok
    s_add_u32 s71, s71, 1
    s_cmp_lt_u32 s71, 200000
    s_cbranch_scc1 L_pr0_26_loop
    s_branch L_pr0_26_ok
L_pr1_27_spin:
    s_mov_b32 s71, 0
L_pr1_27_loop:
    s_add_u32 s72, s77, 0
    buffer_load_dword v32, v6, s[40:43], s72 offen sc1
    s_add_u32 s72, s77, 8192
    buffer_load_dword v33, v6, s[40:43], s72 offen sc1
    s_add_u32 s72, s77, 16384
    buffer_load_dword v34, v6, s[40:43], s72 offen sc1
    s_add_u32 s72, s77, 24576
    buffer_load_dword v35, v6, s[40:43], s72 offen sc1
    s_waitcnt vmcnt(0)
    v_max3_u32 v3, v32, v33, v34
    v_max_u32 v3, v35, v3
    v_cmp_eq_u32 vcc, -1, v3
    s_cbranch_vccz L_pr1_27_ok
    s_add_u32 s71, s71, 1
    s_cmp_lt_u32 s71, 200000
    s_cbranch_scc1 L_pr1_27_loop
    s_branch L_pr1_27_ok
L_pr2_28_s0:
    s_mov_b64 exec, vcc
    s_add_u32 s22, s23, 0
    buffer_load_dwordx4 v[40:43], v7, s[40:43], s22 offen sc1
    s_add_u32 s22, s23, 65536
    buffer_load_dwordx4 v[44:47], v7, s[40:43], s22 offen sc1
    s_add_u32 s22, s23, 131072
    buffer_load_dwordx4 v[48:51], v7, s[40:43], s22 offen sc1
    s_add_u32 s22, s23, 196608
    buffer_load_dwordx4 v[52:55], v7, s[40:43], s22 offen sc1
    s_add_u32 s22, s23, 262144
    buffer_load_dwordx4 v[56:59], v7, s[40:43], s22 offen sc1
    s_add_u32 s22, s23, 327680
    buffer_load_dwordx4 v[60:63], v7, s[40:43], s22 offen sc1
    s_add_u32 s22, s23, 393216
    buffer_load_dwordx4 v[64:67], v7, s[40:43], s22 offen sc1
    s_mov_b64 exec, -1
L_pr2_28_w0:
    s_add_u32 s71, s71, 1
    s_cmp_ge_u32 s71, 200000
    s_waitcnt vmcnt(0)
    s_cbranch_scc1 L_pr2_28_r0
    v_xor_b32 v3, s95, v41
    v_bitop3_b32 v3, v3, v43, s95 bitop3:0xf6
    v_bitop3_b32 v3, v3, v45, s95 bitop3:0xf6
    v_bitop3_b32 v3, v3, v47, s95 bitop3:0xf6
    v_bitop3_b32 v3, v3, v49, s95 bitop3:0xf6
    v_bitop3_b32 v3, v3, v51, s95 bitop3:0xf6
    v_bitop3_b32 v3, v3, v53, s95 bitop3:0xf6
    v_bitop3_b32 v3, v3, v55, s95 bitop3:0xf6
    v_bitop3_b32 v3, v3, v57, s95 bitop3:0xf6
    v_bitop3_b32 v3, v3, v59, s95 bitop3:0xf6
    v_bitop3_b32 v3, v3, v61, s95 bitop3:0xf6
    v_bitop3_b32 v3, v3, v63, s95 bitop3:0xf6
    v_bitop3_b32 v3, v3, v65, s95 bitop3:0xf6
    v_bitop3_b32 v3, v3, v67, s95 bitop3:0xf6
    v_cmp_ne_u32 vcc, 0, v3
    s_cbranch_vccnz L_pr2_28_s0
    s_branch L_pr2_28_r0
L_fin:
L_exit:
    s_endpgm
L_code_end:
.section .rodata,"a"
.p2align 6
.amdhsa_kernel adaLN_cond__gqa_block_cached__glu_gated_geglu__decode_kernel
  .amdhsa_next_free_vgpr 256
  .amdhsa_next_free_sgpr 102
  .amdhsa_accum_offset 256
  .amdhsa_group_segment_fixed_size 0
  .amdhsa_kernarg_size 112
  .amdhsa_user_sgpr_count 2
  .amdhsa_user_sgpr_kernarg_segment_ptr 1
  .amdhsa_system_sgpr_workgroup_id_x 1
.end_amdhsa_kernel
```
